```python
import torch

def _softmax(x, axis=-1):
    return torch.softmax(x, dim=axis)
def _gelu(x):
    return torch.nn.functional.gelu(x, approximate="tanh")
def _silu(x):
    return torch.nn.functional.silu(x)
def _sigmoid(x):
    return torch.sigmoid(x)
def _layernorm(x, axis=-1, eps=1e-5):
    m = x.mean(dim=axis, keepdim=True)
    v = x.var(dim=axis, keepdim=True, unbiased=False)
    return (x - m) / torch.sqrt(v + eps)
def _scatter_add(tgt, idx, src, axis=0):
    return tgt.clone().index_add_(axis, idx, src)
def _segment_sum(src, seg, n):
    out = torch.zeros((n,) + src.shape[1:], dtype=src.dtype)
    return out.index_add_(0, seg, src)
def _pad(x, pw):
    flat = tuple(v for pair in reversed(pw) for v in pair)
    return torch.nn.functional.pad(x, flat)

kernel_name = 'standalone__mpnn_edge_mlp__graph'

def setup_inputs():

    _w = (lambda a: (lambda t: t.to(torch.bfloat16) if t.is_floating_point() else t)(torch.as_tensor(a)))
    N, deg, D, De = 10000, 16, 256, max(16, 1)
    E = N * deg
    return {
        "x": _w((lambda *s: torch.randn(*s, dtype=torch.bfloat16) * 0.05)(N, D)),
        "e_attr": _w((lambda *s: torch.randn(*s, dtype=torch.bfloat16) * 0.4)(E, De)),
        "src": _w((lambda lo, hi, *s: torch.randint(lo, hi, s))(0, N, E).to(torch.int64)),
        "dst": _w((lambda lo, hi, *s: torch.randint(lo, hi, s))(0, N, E).to(torch.int64)),
        "w_msg": _w((lambda *s: torch.randn(*s, dtype=torch.bfloat16) * 0.4)(2 * D + De, D)),
        "w_upd": _w((lambda *s: torch.randn(*s, dtype=torch.bfloat16) * 0.05)(2 * D, D)),
    }

def reference(x, e_attr, src, dst, w_msg, w_upd):
    N, D = x.shape
    m_in = torch.concatenate([x[src], x[dst], e_attr], axis=-1)
    msg = _silu(m_in @ w_msg)
    agg = _segment_sum(msg, dst, N)
    return _silu(torch.concatenate([x, agg], axis=-1) @ w_upd)
```

```asm
; @launch grid=(256,1,1) block=(512,1,1) lds=163840
.amdgcn_target "amdgcn-amd-amdhsa--gfx950"
.text
.globl standalone__mpnn_edge_mlp__graph_kernel
.p2align 8
.type standalone__mpnn_edge_mlp__graph_kernel,@function
standalone__mpnn_edge_mlp__graph_kernel:
    s_cmp_ge_u32 s2, 256
    s_cbranch_scc1 K_end
    s_load_dwordx8 s[72:79], s[0:1], 0
    s_load_dwordx8 s[80:87], s[0:1], 32
    s_load_dwordx2 s[4:5], s[0:1], 64
    v_lshrrev_b32 v128, 6, v0
    v_and_b32 v9, 63, v0
    v_readfirstlane_b32 s3, v128
    v_lshlrev_b32 v252, 4, v9
    v_and_b32 v253, 31, v9
    v_lshrrev_b32 v254, 5, v9
    s_mul_i32 s96, s2, 52429
    s_lshr_b32 s96, s96, 18
    s_sub_u32 s97, s96, s2
    s_add_u32 s97, s97, 215
    s_lshl_b32 s97, s97, 9
    s_mul_i32 s96, s96, 5
    s_sub_u32 s96, s2, s96
    s_lshl_b32 s96, s96, 3
    s_mul_i32 s18, s3, 10624
    v_lshrrev_b32 v116, 2, v9
    v_and_b32 v117, 3, v9
    v_lshlrev_b32 v117, 4, v117
    s_lshl_b32 s6, s3, 6
    s_lshr_b32 s16, s3, 2
    s_and_b32 s17, s3, 3
    v_lshlrev_b32 v128, 2, v254
    v_xor_b32 v128, v128, v253
    v_lshlrev_b32 v128, 4, v128
    s_lshl_b32 s63, s17, 12
    v_lshl_add_u32 v128, v254, 9, v128
    v_add_u32 v212, s63, v128
    v_xor_b32 v213, 0x80, v212
    s_lshl_b32 s7, s17, 1
    v_add_u32 v119, s7, v254
    v_xor_b32 v118, v119, v253
    v_lshlrev_b32 v118, 4, v118
    v_lshl_add_u32 v214, v119, 18, v118
    v_xor_b32 v128, 0x80, v214
    v_add_u32 v215, 0x200000, v128
    s_cmp_ge_u32 s17, 2
    s_cselect_b32 s11, 0x4e0000, 0
    s_sub_u32 s11, 0x400000, s11
    v_add_u32 v216, s11, v214
    v_add_u32 v217, 0x120000, v128
    v_add_u32 v218, 0x320000, v214
    s_add_u32 s11, s96, s7
    s_cmp_ge_u32 s11, 20
    s_cselect_b32 s11, 0x4e0000, 0
    s_lshl_b32 s96, s96, 18
    s_add_u32 s96, s96, s97
    s_sub_u32 s11, s96, s11
    v_add_u32 v219, s11, v128
    s_lshl_b32 s8, s3, 10
    s_lshl_b32 s9, s2, 9
    v_mov_b32 v225, 0
    v_mov_b32 v130, 0
    v_mov_b32 v226, 1
    s_lshl_b32 s10, s2, 7
    s_add_u32 s10, s10, 7864320
    s_lshr_b32 s68, s2, 3
    s_lshl_b32 s68, s68, 13
    s_add_u32 s68, s68, s8
    s_waitcnt lgkmcnt(0)
    s_mov_b32 s40, s72
    s_mov_b32 s41, s73
    s_mov_b32 s42, 0x4e2000
    s_mov_b32 s43, 0x20000
    s_mov_b32 s64, s80
    s_mov_b32 s65, s81
    s_mov_b32 s66, 0x42000
    s_mov_b32 s67, 0x20000
    s_mov_b32 s28, s4
    s_mov_b32 s29, s5
    s_mov_b32 s30, 0x1300000
    s_mov_b32 s31, 0x20000
    s_mov_b32 s92, s82
    s_mov_b32 s93, s83
    s_mov_b32 s94, 0x40000
    s_mov_b32 s95, 0x20000
    s_cmp_ge_u32 s2, 215
    s_cbranch_scc1 K_notp
    s_cmp_lg_u32 s16, 0
    s_cbranch_scc1 K_gx
    s_add_u32 m0, s8, 134144
    s_nop 0
    buffer_load_dwordx4 v214, s[40:43], s9 offen lds
    s_add_u32 m0, s8, 138240
    s_nop 0
    buffer_load_dwordx4 v215, s[40:43], s9 offen lds
    s_add_u32 m0, s8, 142336
    s_nop 0
    buffer_load_dwordx4 v216, s[40:43], s9 offen lds
    s_add_u32 m0, s8, 146432
    s_nop 0
    buffer_load_dwordx4 v217, s[40:43], s9 offen lds
    s_add_u32 m0, s8, 150528
    s_nop 0
    buffer_load_dwordx4 v218, s[40:43], s9 offen lds
    s_add_u32 m0, s8, 154624
    s_nop 0
    buffer_load_dwordx4 v219, s[40:43], s9 offen lds
K_gx:
    s_cmp_lg_u32 s16, 1
    s_cbranch_scc1 K_gw
    s_add_u32 m0, s63, 0
    s_mov_b32 s11, 0
    buffer_load_dwordx4 v212, s[64:67], s11 offen offset:0 lds
    buffer_load_dwordx4 v213, s[64:67], s11 offen offset:1024 lds
    buffer_load_dwordx4 v212, s[64:67], s11 offen offset:2048 lds
    buffer_load_dwordx4 v213, s[64:67], s11 offen offset:3072 lds
K_gw:
    buffer_load_dwordx4 v[200:203], v252, s[64:67], s68 offen
    buffer_load_dwordx4 v[200:203], v252, s[92:95], s68 offen
    s_mov_b32 s5, s68
    s_mov_b32 s44, s76
    s_mov_b32 s45, s77
    s_mov_b32 s46, 0x9c400
    s_mov_b32 s47, 0x20000
    s_mov_b32 s48, s78
    s_mov_b32 s49, s79
    s_mov_b32 s50, 0x9c400
    s_mov_b32 s51, 0x20000
    s_mov_b32 s88, s86
    s_mov_b32 s89, s87
    s_mov_b32 s90, 0x100
    s_mov_b32 s91, 0x20000
    s_mov_b32 s36, s84
    s_mov_b32 s37, s85
    s_mov_b32 s38, 0x4e2000
    s_mov_b32 s39, 0x20000
    s_mov_b32 s32, s74
    s_mov_b32 s33, s75
    s_mov_b32 s34, 0x0
    s_mov_b32 s35, 0x20000
    s_or_b32 s33, s33, 2097152
    s_mov_b32 s24, s28
    s_mov_b32 s25, s29
    s_mov_b32 s26, 0x4e3000
    s_mov_b32 s27, 0x20000
    s_mul_i32 s15, s16, 23296
    s_add_u32 s15, s15, 84992
    s_lshl_b32 s11, s17, 7
    s_add_u32 s20, s11, 4096
    s_add_u32 s21, s11, 3008
    s_add_u32 s22, s11, 1920
    s_add_u32 s23, s11, 832
    s_lshl_b32 s19, s16, 8
    s_add_u32 s19, s19, s2
    s_mul_i32 s14, s19, 4224
    s_add_u32 s14, s14, 5242880
    s_mov_b32 s54, 0
    s_mov_b32 s58, -1
    s_mov_b32 s13, 1
    s_mov_b32 s12, 0
    v_and_b32 v7, 0xff, v0
    v_lshlrev_b32 v7, 4, v7
    v_bfe_u32 v255, v0, 3, 5
    v_mul_u32_u24 v255, 5000, v255
    v_mov_b32 v228, 0
    v_mov_b32 v229, 0
    v_mov_b32 v230, 0
    v_mov_b32 v231, 0
    v_lshlrev_b32 v232, 4, v0
    v_add_u32 v232, 84992, v232
    ds_write_b128 v232, v[228:231] offset:0
    ds_write_b128 v232, v[228:231] offset:8192
    ds_write_b128 v232, v[228:231] offset:16384
    ds_write_b128 v232, v[228:231] offset:24576
    ds_write_b128 v232, v[228:231] offset:32768
    ds_write_b128 v232, v[228:231] offset:40960
    v_mul_u32_u24 v228, 6656, v254
    v_and_b32 v229, 31, v9
    v_lshl_add_u32 v228, v229, 4, v228
    v_add_u32 v1, s15, v228
    s_add_u32 s61, s15, 19968
    v_lshrrev_b32 v228, 3, v9
    v_lshl_add_u32 v3, v228, 4, s61
    v_lshrrev_b32 v228, 1, v9
    v_lshl_add_u32 v6, v228, 2, s61
    v_add_u32 v6, 1664, v6
    v_bfe_u32 v228, v9, 4, 1
    v_bfe_u32 v229, v9, 1, 1
    v_lshl_add_u32 v228, v228, 1, v229
    v_mul_u32_u24 v228, 6656, v228
    v_bfe_u32 v229, v9, 2, 2
    v_lshl_add_u32 v229, v254, 2, v229
    v_lshl_add_u32 v228, v229, 4, v228
    v_and_b32 v229, 1, v9
    v_lshl_add_u32 v228, v229, 3, v228
    v_add_u32 v2, s15, v228
    v_lshrrev_b32 v240, 4, v9
    v_bfe_u32 v241, v9, 2, 2
    v_and_b32 v242, 15, v9
    v_bfe_u32 v228, v9, 3, 2
    v_xor_b32 v228, v228, v9
    v_and_b32 v228, 7, v228
    v_lshlrev_b32 v10, 4, v228
    v_xor_b32 v228, v240, v9
    v_and_b32 v228, 1, v228
    v_lshlrev_b32 v15, 4, v228
    v_lshlrev_b32 v228, 3, v254
    v_sub_u32 v228, v253, v228
    v_and_b32 v229, 1, v228
    v_lshlrev_b32 v229, 4, v229
    v_mov_b32 v230, 0x3f80
    v_lshlrev_b32 v229, v229, v230
    v_ashrrev_i32 v228, 1, v228
    v_cmp_eq_u32 vcc, 0, v228
    v_cndmask_b32 v156, 0, v229, vcc
    v_cmp_eq_u32 vcc, 1, v228
    v_cndmask_b32 v157, 0, v229, vcc
    v_cmp_eq_u32 vcc, 2, v228
    v_cndmask_b32 v158, 0, v229, vcc
    v_cmp_eq_u32 vcc, 3, v228
    v_cndmask_b32 v159, 0, v229, vcc
    v_cmp_eq_u32 vcc, 8, v228
    v_cndmask_b32 v160, 0, v229, vcc
    v_cmp_eq_u32 vcc, 9, v228
    v_cndmask_b32 v161, 0, v229, vcc
    v_cmp_eq_u32 vcc, 10, v228
    v_cndmask_b32 v162, 0, v229, vcc
    v_cmp_eq_u32 vcc, 11, v228
    v_cndmask_b32 v163, 0, v229, vcc
    v_xor_b32 v228, v241, v254
    v_lshlrev_b32 v228, 4, v228
    v_lshrrev_b32 v229, 2, v253
    v_lshl_add_u32 v228, v229, 7, v228
    v_mul_u32_u24 v229, 68, v117
    v_add_u32 v228, v228, v229
    v_add_u32 v4, s18, v228
    v_xor_b32 v5, 32, v4
    v_bfe_u32 v228, v9, 3, 1
    v_xor_b32 v228, v228, v254
    v_lshlrev_b32 v228, 4, v228
    v_lshl_add_u32 v228, v253, 5, v228
    v_add_u32 v8, s18, v228
    v_lshl_add_u32 v228, v240, 3, v241
    v_lshl_add_u32 v228, v228, 9, v117
    v_xor_b32 v229, s3, v241
    v_lshl_add_u32 v220, v229, 6, v228
    v_add_u32 v148, 0x10000, v220
    v_xor_b32 v228, v240, v242
    v_lshlrev_b32 v228, 4, v228
    v_lshl_add_u32 v228, v242, 9, v228
    v_add_u32 v221, 134144, v228
    v_xor_b32 v149, s6, v221
    v_lshl_add_u32 v228, v116, 18, v117
    v_add_u32 v229, 0x400000, v228
    v_subrev_u32 v243, 0xe0000, v228
    v_cmp_le_u32 vcc, 4, v116
    v_add_u32 v230, 0x320000, v228
    v_cndmask_b32 v229, v229, v243, vcc
    v_and_b32 v243, 7, v253
    v_xor_b32 v243, v243, v254
    v_lshlrev_b32 v243, 4, v243
    v_lshl_add_u32 v231, v253, 7, v243
    v_cmp_le_u32 vcc, 4, v242
    v_add_u32 v243, 16, v242
    v_subrev_u32 v244, 4, v242
    v_cndmask_b32 v243, v243, v244, vcc
    v_mov_b32 v245, 42496
    v_cndmask_b32 v244, 0, v245, vcc
    v_add_u32 v246, 12, v242
    v_and_b32 v247, 7, v242
    v_xor_b32 v247, v247, v240
    v_lshlrev_b32 v247, 4, v247
    v_lshl_add_u32 v247, v242, 7, v247
    v_add_u32 v232, 0, v247
    v_xor_b32 v236, 64, v232
    v_and_b32 v247, 7, v243
    v_xor_b32 v247, v247, v240
    v_lshlrev_b32 v247, 4, v247
    v_lshl_add_u32 v247, v243, 7, v247
    v_add_u32 v233, v244, v247
    v_xor_b32 v237, 64, v233
    v_and_b32 v247, 7, v246
    v_xor_b32 v247, v247, v240
    v_lshlrev_b32 v247, 4, v247
    v_lshl_add_u32 v247, v246, 7, v247
    v_add_u32 v234, v245, v247
    v_xor_b32 v238, 64, v234
    v_lshlrev_b32 v243, 6, v242
    v_lshl_add_u32 v235, v240, 4, v243
    v_add_u32 v243, 158720, v252
    ds_write_b128 v243, v[228:231] offset:0
    ds_write_b128 v243, v[232:235] offset:1024
    ds_write_b128 v243, v[236:239] offset:2048
    s_mul_i32 s11, s3, 3072
    s_add_u32 s11, s11, 134144
    v_add_u32 v150, s11, v235
    s_add_u32 s11, s8, 134144
    v_add_u32 v223, s11, v252
    s_mul_i32 s11, s17, 6144
    s_mul_i32 s61, s16, 1280
    s_add_u32 s11, s11, s61
    s_add_u32 s11, s11, 134144
    v_lshl_add_u32 v243, v254, 3, v241
    v_and_b32 v244, 1, v240
    v_lshl_add_u32 v243, v243, 1, v244
    v_lshrrev_b32 v244, 1, v117
    v_lshl_add_u32 v243, v243, 5, v244
    v_add_u32 v151, s11, v243
    v_mov_b32 v136, 0
    v_mov_b32 v137, 0
    v_mov_b32 v138, 0
    v_mov_b32 v139, 0
    v_mov_b32 v144, 0
    v_mov_b32 v145, 0
    v_mov_b32 v146, 0
    v_mov_b32 v147, 0
    s_lshl_b32 s11, s3, 5
    v_add_u32 v152, s11, v253
    v_lshlrev_b32 v152, 7, v152
    s_mov_b32 s68, 0xbfb8aa3b
    s_mov_b32 s69, s68
    s_cmp_lg_u32 s16, 1
    s_cbranch_scc1 K_gw2
    s_add_u32 m0, s63, 16384
    s_mov_b32 s11, 16384
    buffer_load_dwordx4 v212, s[64:67], s11 offen offset:0 lds
    buffer_load_dwordx4 v213, s[64:67], s11 offen offset:1024 lds
    buffer_load_dwordx4 v212, s[64:67], s11 offen offset:2048 lds
    buffer_load_dwordx4 v213, s[64:67], s11 offen offset:3072 lds
    s_add_u32 m0, s63, 32768
    s_mov_b32 s11, 32768
    buffer_load_dwordx4 v212, s[64:67], s11 offen offset:0 lds
    buffer_load_dwordx4 v213, s[64:67], s11 offen offset:1024 lds
    buffer_load_dwordx4 v212, s[64:67], s11 offen offset:2048 lds
    buffer_load_dwordx4 v213, s[64:67], s11 offen offset:3072 lds
    s_add_u32 m0, s63, 49152
    s_mov_b32 s11, 49152
    buffer_load_dwordx4 v212, s[64:67], s11 offen offset:0 lds
    buffer_load_dwordx4 v213, s[64:67], s11 offen offset:1024 lds
    buffer_load_dwordx4 v212, s[64:67], s11 offen offset:2048 lds
    buffer_load_dwordx4 v213, s[64:67], s11 offen offset:3072 lds
    s_add_u32 m0, s63, 65536
    s_mov_b32 s11, 65536
    buffer_load_dwordx4 v212, s[64:67], s11 offen offset:0 lds
    buffer_load_dwordx4 v213, s[64:67], s11 offen offset:1024 lds
    buffer_load_dwordx4 v212, s[64:67], s11 offen offset:2048 lds
    buffer_load_dwordx4 v213, s[64:67], s11 offen offset:3072 lds
K_gw2:
    s_cmp_lg_u32 s16, 0
    s_cbranch_scc1 K_gx2
    s_waitcnt vmcnt(2)
K_gx2:
    s_waitcnt vmcnt(18)
    s_cmp_eq_u32 s16, 0
    s_cselect_b64 vcc, -1, 0
    s_barrier
    ds_read_b64_tr_b16 v[112:113], v220 offset:0
    ds_read_b64_tr_b16 v[114:115], v220 offset:2048
    ds_read_b64_tr_b16 v[116:117], v220 offset:8
    ds_read_b64_tr_b16 v[118:119], v220 offset:2056
    ds_read_b128 v[16:19], v221 offset:0
    ds_read_b128 v[20:23], v221 offset:8192
    ds_read_b128 v[24:27], v221 offset:16384
    s_waitcnt vmcnt(12) lgkmcnt(0)
    s_barrier
    s_cbranch_vccnz K_d0
    v_mfma_f32_16x16x32_bf16 v[164:167], v[112:115], v[16:19], 0
    ds_read_b64_tr_b16 v[120:121], v220 offset:16384
    ds_read_b64_tr_b16 v[122:123], v220 offset:18432
    s_add_u32 m0, s63, 0
    s_mov_b32 s11, 81920
    buffer_load_dwordx4 v212, s[64:67], s11 offen offset:0 lds
    v_mfma_f32_16x16x32_bf16 v[168:171], v[116:119], v[16:19], 0
    ds_read_b64_tr_b16 v[124:125], v220 offset:16392
    ds_read_b64_tr_b16 v[126:127], v220 offset:18440
    buffer_load_dwordx4 v213, s[64:67], s11 offen offset:1024 lds
    v_mfma_f32_16x16x32_bf16 v[172:175], v[112:115], v[20:23], 0
    v_xor_b32 v129, 64, v221
    ds_read_b128 v[28:31], v129 offset:0
    buffer_load_dwordx4 v212, s[64:67], s11 offen offset:2048 lds
    v_mfma_f32_16x16x32_bf16 v[176:179], v[116:119], v[20:23], 0
    ds_read_b128 v[32:35], v129 offset:8192
    ds_read_b128 v[36:39], v129 offset:16384
    buffer_load_dwordx4 v213, s[64:67], s11 offen offset:3072 lds
    v_mfma_f32_16x16x32_bf16 v[180:183], v[112:115], v[24:27], 0
    v_mfma_f32_16x16x32_bf16 v[184:187], v[116:119], v[24:27], 0
    s_branch K_e0
K_d0:
    v_mfma_f32_16x16x32_bf16 v[164:167], v[112:115], v[16:19], 0
    ds_read_b64_tr_b16 v[120:121], v220 offset:16384
    ds_read_b64_tr_b16 v[122:123], v220 offset:18432
    v_mfma_f32_16x16x32_bf16 v[168:171], v[116:119], v[16:19], 0
    ds_read_b64_tr_b16 v[124:125], v220 offset:16392
    ds_read_b64_tr_b16 v[126:127], v220 offset:18440
    v_mfma_f32_16x16x32_bf16 v[172:175], v[112:115], v[20:23], 0
    v_xor_b32 v129, 64, v221
    ds_read_b128 v[28:31], v129 offset:0
    v_mfma_f32_16x16x32_bf16 v[176:179], v[116:119], v[20:23], 0
    ds_read_b128 v[32:35], v129 offset:8192
    ds_read_b128 v[36:39], v129 offset:16384
    v_mfma_f32_16x16x32_bf16 v[180:183], v[112:115], v[24:27], 0
    v_mfma_f32_16x16x32_bf16 v[184:187], v[116:119], v[24:27], 0
K_e0:
    s_waitcnt vmcnt(12) lgkmcnt(0)
    s_barrier
    s_cbranch_vccnz K_d1
    v_mfma_f32_16x16x32_bf16 v[164:167], v[120:123], v[28:31], v[164:167]
    ds_read_b64_tr_b16 v[112:113], v220 offset:32768
    ds_read_b64_tr_b16 v[114:115], v220 offset:34816
    s_add_u32 m0, s63, 16384
    s_mov_b32 s11, 98304
    buffer_load_dwordx4 v212, s[64:67], s11 offen offset:0 lds
    v_mfma_f32_16x16x32_bf16 v[168:171], v[124:127], v[28:31], v[168:171]
    ds_read_b64_tr_b16 v[116:117], v220 offset:32776
    ds_read_b64_tr_b16 v[118:119], v220 offset:34824
    buffer_load_dwordx4 v213, s[64:67], s11 offen offset:1024 lds
    v_mfma_f32_16x16x32_bf16 v[172:175], v[120:123], v[32:35], v[172:175]
    v_xor_b32 v128, 128, v221
    ds_read_b128 v[40:43], v128 offset:0
    buffer_load_dwordx4 v212, s[64:67], s11 offen offset:2048 lds
    v_mfma_f32_16x16x32_bf16 v[176:179], v[124:127], v[32:35], v[176:179]
    ds_read_b128 v[44:47], v128 offset:8192
    ds_read_b128 v[48:51], v128 offset:16384
    buffer_load_dwordx4 v213, s[64:67], s11 offen offset:3072 lds
    v_mfma_f32_16x16x32_bf16 v[180:183], v[120:123], v[36:39], v[180:183]
    v_mfma_f32_16x16x32_bf16 v[184:187], v[124:127], v[36:39], v[184:187]
    s_branch K_e1
K_d1:
    v_mfma_f32_16x16x32_bf16 v[164:167], v[120:123], v[28:31], v[164:167]
    ds_read_b64_tr_b16 v[112:113], v220 offset:32768
    ds_read_b64_tr_b16 v[114:115], v220 offset:34816
    v_mfma_f32_16x16x32_bf16 v[168:171], v[124:127], v[28:31], v[168:171]
    ds_read_b64_tr_b16 v[116:117], v220 offset:32776
    ds_read_b64_tr_b16 v[118:119], v220 offset:34824
    v_mfma_f32_16x16x32_bf16 v[172:175], v[120:123], v[32:35], v[172:175]
    v_xor_b32 v128, 128, v221
    ds_read_b128 v[40:43], v128 offset:0
    v_mfma_f32_16x16x32_bf16 v[176:179], v[124:127], v[32:35], v[176:179]
    ds_read_b128 v[44:47], v128 offset:8192
    ds_read_b128 v[48:51], v128 offset:16384
    v_mfma_f32_16x16x32_bf16 v[180:183], v[120:123], v[36:39], v[180:183]
    v_mfma_f32_16x16x32_bf16 v[184:187], v[124:127], v[36:39], v[184:187]
K_e1:
    s_waitcnt vmcnt(12) lgkmcnt(0)
    s_barrier
    s_cbranch_vccnz K_d2
    v_mfma_f32_16x16x32_bf16 v[164:167], v[112:115], v[40:43], v[164:167]
    ds_read_b64_tr_b16 v[120:121], v220 offset:49152
    ds_read_b64_tr_b16 v[122:123], v220 offset:51200
    s_add_u32 m0, s63, 32768
    s_mov_b32 s11, 114688
    buffer_load_dwordx4 v212, s[64:67], s11 offen offset:0 lds
    v_mfma_f32_16x16x32_bf16 v[168:171], v[116:119], v[40:43], v[168:171]
    ds_read_b64_tr_b16 v[124:125], v220 offset:49160
    ds_read_b64_tr_b16 v[126:127], v220 offset:51208
    buffer_load_dwordx4 v213, s[64:67], s11 offen offset:1024 lds
    v_mfma_f32_16x16x32_bf16 v[172:175], v[112:115], v[44:47], v[172:175]
    v_xor_b32 v129, 192, v221
    ds_read_b128 v[52:55], v129 offset:0
    buffer_load_dwordx4 v212, s[64:67], s11 offen offset:2048 lds
    v_mfma_f32_16x16x32_bf16 v[176:179], v[116:119], v[44:47], v[176:179]
    ds_read_b128 v[56:59], v129 offset:8192
    ds_read_b128 v[60:63], v129 offset:16384
    buffer_load_dwordx4 v213, s[64:67], s11 offen offset:3072 lds
    v_mfma_f32_16x16x32_bf16 v[180:183], v[112:115], v[48:51], v[180:183]
    v_mfma_f32_16x16x32_bf16 v[184:187], v[116:119], v[48:51], v[184:187]
    s_branch K_e2
K_d2:
    v_mfma_f32_16x16x32_bf16 v[164:167], v[112:115], v[40:43], v[164:167]
    ds_read_b64_tr_b16 v[120:121], v220 offset:49152
    ds_read_b64_tr_b16 v[122:123], v220 offset:51200
    v_mfma_f32_16x16x32_bf16 v[168:171], v[116:119], v[40:43], v[168:171]
    ds_read_b64_tr_b16 v[124:125], v220 offset:49160
    ds_read_b64_tr_b16 v[126:127], v220 offset:51208
    v_mfma_f32_16x16x32_bf16 v[172:175], v[112:115], v[44:47], v[172:175]
    v_xor_b32 v129, 192, v221
    ds_read_b128 v[52:55], v129 offset:0
    v_mfma_f32_16x16x32_bf16 v[176:179], v[116:119], v[44:47], v[176:179]
    ds_read_b128 v[56:59], v129 offset:8192
    ds_read_b128 v[60:63], v129 offset:16384
    v_mfma_f32_16x16x32_bf16 v[180:183], v[112:115], v[48:51], v[180:183]
    v_mfma_f32_16x16x32_bf16 v[184:187], v[116:119], v[48:51], v[184:187]
K_e2:
    s_waitcnt vmcnt(12) lgkmcnt(0)
    s_barrier
    s_cbranch_vccnz K_d3
    v_mfma_f32_16x16x32_bf16 v[164:167], v[120:123], v[52:55], v[164:167]
    ds_read_b64_tr_b16 v[112:113], v148 offset:0
    ds_read_b64_tr_b16 v[114:115], v148 offset:2048
    s_add_u32 m0, s63, 49152
    s_mov_b32 s11, 0
    buffer_load_dwordx4 v212, s[92:95], s11 offen offset:0 lds
    v_mfma_f32_16x16x32_bf16 v[168:171], v[124:127], v[52:55], v[168:171]
    ds_read_b64_tr_b16 v[116:117], v148 offset:8
    ds_read_b64_tr_b16 v[118:119], v148 offset:2056
    buffer_load_dwordx4 v213, s[92:95], s11 offen offset:1024 lds
    v_mfma_f32_16x16x32_bf16 v[172:175], v[120:123], v[56:59], v[172:175]
    v_xor_b32 v128, 256, v221
    ds_read_b128 v[64:67], v128 offset:0
    buffer_load_dwordx4 v212, s[92:95], s11 offen offset:2048 lds
    v_mfma_f32_16x16x32_bf16 v[176:179], v[124:127], v[56:59], v[176:179]
    ds_read_b128 v[68:71], v128 offset:8192
    ds_read_b128 v[72:75], v128 offset:16384
    buffer_load_dwordx4 v213, s[92:95], s11 offen offset:3072 lds
    v_mfma_f32_16x16x32_bf16 v[180:183], v[120:123], v[60:63], v[180:183]
    v_mfma_f32_16x16x32_bf16 v[184:187], v[124:127], v[60:63], v[184:187]
    s_branch K_e3
K_d3:
    v_mfma_f32_16x16x32_bf16 v[164:167], v[120:123], v[52:55], v[164:167]
    ds_read_b64_tr_b16 v[112:113], v148 offset:0
    ds_read_b64_tr_b16 v[114:115], v148 offset:2048
    v_mfma_f32_16x16x32_bf16 v[168:171], v[124:127], v[52:55], v[168:171]
    ds_read_b64_tr_b16 v[116:117], v148 offset:8
    ds_read_b64_tr_b16 v[118:119], v148 offset:2056
    v_mfma_f32_16x16x32_bf16 v[172:175], v[120:123], v[56:59], v[172:175]
    v_xor_b32 v128, 256, v221
    ds_read_b128 v[64:67], v128 offset:0
    v_mfma_f32_16x16x32_bf16 v[176:179], v[124:127], v[56:59], v[176:179]
    ds_read_b128 v[68:71], v128 offset:8192
    ds_read_b128 v[72:75], v128 offset:16384
    v_mfma_f32_16x16x32_bf16 v[180:183], v[120:123], v[60:63], v[180:183]
    v_mfma_f32_16x16x32_bf16 v[184:187], v[124:127], v[60:63], v[184:187]
K_e3:
    s_waitcnt vmcnt(12) lgkmcnt(0)
    s_barrier
    s_cbranch_vccnz K_d4
    v_mfma_f32_16x16x32_bf16 v[164:167], v[112:115], v[64:67], v[164:167]
    ds_read_b64_tr_b16 v[120:121], v220 offset:0
    ds_read_b64_tr_b16 v[122:123], v220 offset:2048
    s_add_u32 m0, s63, 65536
    s_mov_b32 s11, 16384
    buffer_load_dwordx4 v212, s[92:95], s11 offen offset:0 lds
    v_mfma_f32_16x16x32_bf16 v[168:171], v[116:119], v[64:67], v[168:171]
    ds_read_b64_tr_b16 v[124:125], v220 offset:8
    ds_read_b64_tr_b16 v[126:127], v220 offset:2056
    buffer_load_dwordx4 v213, s[92:95], s11 offen offset:1024 lds
    v_mfma_f32_16x16x32_bf16 v[172:175], v[112:115], v[68:71], v[172:175]
    v_xor_b32 v129, 320, v221
    ds_read_b128 v[76:79], v129 offset:0
    buffer_load_dwordx4 v212, s[92:95], s11 offen offset:2048 lds
    v_mfma_f32_16x16x32_bf16 v[176:179], v[116:119], v[68:71], v[176:179]
    ds_read_b128 v[80:83], v129 offset:8192
    ds_read_b128 v[84:87], v129 offset:16384
    buffer_load_dwordx4 v213, s[92:95], s11 offen offset:3072 lds
    v_mfma_f32_16x16x32_bf16 v[180:183], v[112:115], v[72:75], v[180:183]
    v_mfma_f32_16x16x32_bf16 v[184:187], v[116:119], v[72:75], v[184:187]
    s_branch K_e4
K_d4:
    v_mfma_f32_16x16x32_bf16 v[164:167], v[112:115], v[64:67], v[164:167]
    ds_read_b64_tr_b16 v[120:121], v220 offset:0
    ds_read_b64_tr_b16 v[122:123], v220 offset:2048
    v_mfma_f32_16x16x32_bf16 v[168:171], v[116:119], v[64:67], v[168:171]
    ds_read_b64_tr_b16 v[124:125], v220 offset:8
    ds_read_b64_tr_b16 v[126:127], v220 offset:2056
    v_mfma_f32_16x16x32_bf16 v[172:175], v[112:115], v[68:71], v[172:175]
    v_xor_b32 v129, 320, v221
    ds_read_b128 v[76:79], v129 offset:0
    v_mfma_f32_16x16x32_bf16 v[176:179], v[116:119], v[68:71], v[176:179]
    ds_read_b128 v[80:83], v129 offset:8192
    ds_read_b128 v[84:87], v129 offset:16384
    v_mfma_f32_16x16x32_bf16 v[180:183], v[112:115], v[72:75], v[180:183]
    v_mfma_f32_16x16x32_bf16 v[184:187], v[116:119], v[72:75], v[184:187]
K_e4:
    s_waitcnt vmcnt(12) lgkmcnt(0)
    s_barrier
    s_cbranch_vccnz K_d5
    v_mfma_f32_16x16x32_bf16 v[164:167], v[120:123], v[76:79], v[164:167]
    ds_read_b64_tr_b16 v[112:113], v220 offset:16384
    ds_read_b64_tr_b16 v[114:115], v220 offset:18432
    s_add_u32 m0, s63, 0
    s_mov_b32 s11, 32768
    buffer_load_dwordx4 v212, s[92:95], s11 offen offset:0 lds
    v_mfma_f32_16x16x32_bf16 v[168:171], v[124:127], v[76:79], v[168:171]
    ds_read_b64_tr_b16 v[116:117], v220 offset:16392
    ds_read_b64_tr_b16 v[118:119], v220 offset:18440
    buffer_load_dwordx4 v213, s[92:95], s11 offen offset:1024 lds
    v_mfma_f32_16x16x32_bf16 v[172:175], v[120:123], v[80:83], v[172:175]
    v_xor_b32 v128, 384, v221
    ds_read_b128 v[88:91], v128 offset:0
    buffer_load_dwordx4 v212, s[92:95], s11 offen offset:2048 lds
    v_mfma_f32_16x16x32_bf16 v[176:179], v[124:127], v[80:83], v[176:179]
    ds_read_b128 v[92:95], v128 offset:8192
    ds_read_b128 v[96:99], v128 offset:16384
    buffer_load_dwordx4 v213, s[92:95], s11 offen offset:3072 lds
    v_mfma_f32_16x16x32_bf16 v[180:183], v[120:123], v[84:87], v[180:183]
    v_mfma_f32_16x16x32_bf16 v[184:187], v[124:127], v[84:87], v[184:187]
    s_branch K_e5
K_d5:
    v_mfma_f32_16x16x32_bf16 v[164:167], v[120:123], v[76:79], v[164:167]
    ds_read_b64_tr_b16 v[112:113], v220 offset:16384
    ds_read_b64_tr_b16 v[114:115], v220 offset:18432
    v_mfma_f32_16x16x32_bf16 v[168:171], v[124:127], v[76:79], v[168:171]
    ds_read_b64_tr_b16 v[116:117], v220 offset:16392
    ds_read_b64_tr_b16 v[118:119], v220 offset:18440
    v_mfma_f32_16x16x32_bf16 v[172:175], v[120:123], v[80:83], v[172:175]
    v_xor_b32 v128, 384, v221
    ds_read_b128 v[88:91], v128 offset:0
    v_mfma_f32_16x16x32_bf16 v[176:179], v[124:127], v[80:83], v[176:179]
    ds_read_b128 v[92:95], v128 offset:8192
    ds_read_b128 v[96:99], v128 offset:16384
    v_mfma_f32_16x16x32_bf16 v[180:183], v[120:123], v[84:87], v[180:183]
    v_mfma_f32_16x16x32_bf16 v[184:187], v[124:127], v[84:87], v[184:187]
K_e5:
    s_waitcnt vmcnt(12) lgkmcnt(0)
    s_barrier
    s_cbranch_vccnz K_d6
    v_mfma_f32_16x16x32_bf16 v[164:167], v[112:115], v[88:91], v[164:167]
    ds_read_b64_tr_b16 v[120:121], v220 offset:32768
    ds_read_b64_tr_b16 v[122:123], v220 offset:34816
    s_add_u32 m0, s63, 16384
    s_mov_b32 s11, 49152
    buffer_load_dwordx4 v212, s[92:95], s11 offen offset:0 lds
    v_mfma_f32_16x16x32_bf16 v[168:171], v[116:119], v[88:91], v[168:171]
    ds_read_b64_tr_b16 v[124:125], v220 offset:32776
    ds_read_b64_tr_b16 v[126:127], v220 offset:34824
    buffer_load_dwordx4 v213, s[92:95], s11 offen offset:1024 lds
    v_mfma_f32_16x16x32_bf16 v[172:175], v[112:115], v[92:95], v[172:175]
    v_xor_b32 v129, 448, v221
    ds_read_b128 v[100:103], v129 offset:0
    buffer_load_dwordx4 v212, s[92:95], s11 offen offset:2048 lds
    v_mfma_f32_16x16x32_bf16 v[176:179], v[116:119], v[92:95], v[176:179]
    ds_read_b128 v[104:107], v129 offset:8192
    ds_read_b128 v[108:111], v129 offset:16384
    buffer_load_dwordx4 v213, s[92:95], s11 offen offset:3072 lds
    v_mfma_f32_16x16x32_bf16 v[180:183], v[112:115], v[96:99], v[180:183]
    v_mfma_f32_16x16x32_bf16 v[184:187], v[116:119], v[96:99], v[184:187]
    s_branch K_e6
K_d6:
    v_mfma_f32_16x16x32_bf16 v[164:167], v[112:115], v[88:91], v[164:167]
    ds_read_b64_tr_b16 v[120:121], v220 offset:32768
    ds_read_b64_tr_b16 v[122:123], v220 offset:34816
    v_mfma_f32_16x16x32_bf16 v[168:171], v[116:119], v[88:91], v[168:171]
    ds_read_b64_tr_b16 v[124:125], v220 offset:32776
    ds_read_b64_tr_b16 v[126:127], v220 offset:34824
    v_mfma_f32_16x16x32_bf16 v[172:175], v[112:115], v[92:95], v[172:175]
    v_xor_b32 v129, 448, v221
    ds_read_b128 v[100:103], v129 offset:0
    v_mfma_f32_16x16x32_bf16 v[176:179], v[116:119], v[92:95], v[176:179]
    ds_read_b128 v[104:107], v129 offset:8192
    ds_read_b128 v[108:111], v129 offset:16384
    v_mfma_f32_16x16x32_bf16 v[180:183], v[112:115], v[96:99], v[180:183]
    v_mfma_f32_16x16x32_bf16 v[184:187], v[116:119], v[96:99], v[184:187]
K_e6:
    s_waitcnt vmcnt(12) lgkmcnt(0)
    s_barrier
    s_cbranch_vccnz K_d7
    v_mfma_f32_16x16x32_bf16 v[164:167], v[120:123], v[100:103], v[164:167]
    ds_read_b64_tr_b16 v[112:113], v220 offset:49152
    ds_read_b64_tr_b16 v[114:115], v220 offset:51200
    s_add_u32 m0, s63, 32768
    s_mov_b32 s11, 65536
    buffer_load_dwordx4 v212, s[92:95], s11 offen offset:0 lds
    v_mfma_f32_16x16x32_bf16 v[168:171], v[124:127], v[100:103], v[168:171]
    ds_read_b64_tr_b16 v[116:117], v220 offset:49160
    ds_read_b64_tr_b16 v[118:119], v220 offset:51208
    buffer_load_dwordx4 v213, s[92:95], s11 offen offset:1024 lds
    v_mfma_f32_16x16x32_bf16 v[172:175], v[120:123], v[104:107], v[172:175]
    buffer_load_dwordx4 v212, s[92:95], s11 offen offset:2048 lds
    v_mfma_f32_16x16x32_bf16 v[176:179], v[124:127], v[104:107], v[176:179]
    buffer_load_dwordx4 v213, s[92:95], s11 offen offset:3072 lds
    v_mfma_f32_16x16x32_bf16 v[180:183], v[120:123], v[108:111], v[180:183]
    v_mfma_f32_16x16x32_bf16 v[184:187], v[124:127], v[108:111], v[184:187]
    s_branch K_e7
K_d7:
    v_mfma_f32_16x16x32_bf16 v[164:167], v[120:123], v[100:103], v[164:167]
    ds_read_b64_tr_b16 v[112:113], v220 offset:49152
    ds_read_b64_tr_b16 v[114:115], v220 offset:51200
    v_mfma_f32_16x16x32_bf16 v[168:171], v[124:127], v[100:103], v[168:171]
    ds_read_b64_tr_b16 v[116:117], v220 offset:49160
    ds_read_b64_tr_b16 v[118:119], v220 offset:51208
    v_mfma_f32_16x16x32_bf16 v[172:175], v[120:123], v[104:107], v[172:175]
    v_mfma_f32_16x16x32_bf16 v[176:179], v[124:127], v[104:107], v[176:179]
    v_mfma_f32_16x16x32_bf16 v[180:183], v[120:123], v[108:111], v[180:183]
    v_mfma_f32_16x16x32_bf16 v[184:187], v[124:127], v[108:111], v[184:187]
K_e7:
    s_add_u32 s7, s9, 4096
    s_lshl_b32 s4, s3, 14
    s_waitcnt vmcnt(12) lgkmcnt(0)
    s_barrier
    s_cbranch_vccnz K_d8
    v_mfma_f32_16x16x32_bf16 v[228:231], v[112:115], v[16:19], 0
    ds_read_b64_tr_b16 v[120:121], v148 offset:0
    ds_read_b64_tr_b16 v[122:123], v148 offset:2048
    s_add_u32 m0, s63, 49152
    s_mov_b32 s11, 81920
    buffer_load_dwordx4 v212, s[92:95], s11 offen offset:0 lds
    v_mul_f32 v164, s68, v164
    v_mul_f32 v165, s68, v165
    v_mul_f32 v166, s68, v166
    v_mul_f32 v167, s68, v167
    v_mul_f32 v168, s68, v168
    v_mul_f32 v169, s68, v169
    v_mul_f32 v170, s68, v170
    v_mfma_f32_16x16x32_bf16 v[232:235], v[116:119], v[16:19], 0
    ds_read_b64_tr_b16 v[124:125], v148 offset:8
    ds_read_b64_tr_b16 v[126:127], v148 offset:2056
    buffer_load_dwordx4 v213, s[92:95], s11 offen offset:1024 lds
    v_mul_f32 v171, s68, v171
    v_cvt_pk_bf16_f32 v188, v164, v165
    v_cvt_pk_bf16_f32 v189, v166, v167
    v_cvt_pk_bf16_f32 v190, v168, v169
    v_cvt_pk_bf16_f32 v191, v170, v171
    ds_write_b128 v149, v[188:191] offset:0
    v_mul_f32 v172, s68, v172
    v_mfma_f32_16x16x32_bf16 v[236:239], v[112:115], v[20:23], 0
    buffer_load_dwordx4 v212, s[92:95], s11 offen offset:2048 lds
    v_mul_f32 v173, s68, v173
    v_mul_f32 v174, s68, v174
    v_mul_f32 v175, s68, v175
    v_mul_f32 v176, s68, v176
    v_mul_f32 v177, s68, v177
    v_mul_f32 v178, s68, v178
    v_mul_f32 v179, s68, v179
    v_mfma_f32_16x16x32_bf16 v[240:243], v[116:119], v[20:23], 0
    buffer_load_dwordx4 v213, s[92:95], s11 offen offset:3072 lds
    v_cvt_pk_bf16_f32 v192, v172, v173
    v_cvt_pk_bf16_f32 v193, v174, v175
    v_cvt_pk_bf16_f32 v194, v176, v177
    v_cvt_pk_bf16_f32 v195, v178, v179
    ds_write_b128 v149, v[192:195] offset:8192
    v_mul_f32 v180, s68, v180
    v_mul_f32 v181, s68, v181
    v_mfma_f32_16x16x32_bf16 v[244:247], v[112:115], v[24:27], 0
    v_mul_f32 v182, s68, v182
    v_mul_f32 v183, s68, v183
    v_mul_f32 v184, s68, v184
    v_mul_f32 v185, s68, v185
    v_mul_f32 v186, s68, v186
    v_mul_f32 v187, s68, v187
    v_cvt_pk_bf16_f32 v196, v180, v181
    v_mfma_f32_16x16x32_bf16 v[248:251], v[116:119], v[24:27], 0
    v_cvt_pk_bf16_f32 v197, v182, v183
    v_cvt_pk_bf16_f32 v198, v184, v185
    v_cvt_pk_bf16_f32 v199, v186, v187
    ds_write_b128 v149, v[196:199] offset:16384
    s_branch K_e8
K_d8:
    v_mfma_f32_16x16x32_bf16 v[228:231], v[112:115], v[16:19], 0
    ds_read_b64_tr_b16 v[120:121], v148 offset:0
    ds_read_b64_tr_b16 v[122:123], v148 offset:2048
    v_mul_f32 v164, s68, v164
    v_mul_f32 v165, s68, v165
    v_mul_f32 v166, s68, v166
    v_mul_f32 v167, s68, v167
    v_mul_f32 v168, s68, v168
    v_mul_f32 v169, s68, v169
    v_mul_f32 v170, s68, v170
    v_mfma_f32_16x16x32_bf16 v[232:235], v[116:119], v[16:19], 0
    ds_read_b64_tr_b16 v[124:125], v148 offset:8
    ds_read_b64_tr_b16 v[126:127], v148 offset:2056
    v_mul_f32 v171, s68, v171
    v_cvt_pk_bf16_f32 v188, v164, v165
    v_cvt_pk_bf16_f32 v189, v166, v167
    v_cvt_pk_bf16_f32 v190, v168, v169
    v_cvt_pk_bf16_f32 v191, v170, v171
    ds_write_b128 v149, v[188:191] offset:0
    v_mul_f32 v172, s68, v172
    v_mfma_f32_16x16x32_bf16 v[236:239], v[112:115], v[20:23], 0
    v_mul_f32 v173, s68, v173
    v_mul_f32 v174, s68, v174
    v_mul_f32 v175, s68, v175
    v_mul_f32 v176, s68, v176
    v_mul_f32 v177, s68, v177
    v_mul_f32 v178, s68, v178
    v_mul_f32 v179, s68, v179
    v_mfma_f32_16x16x32_bf16 v[240:243], v[116:119], v[20:23], 0
    v_cvt_pk_bf16_f32 v192, v172, v173
    v_cvt_pk_bf16_f32 v193, v174, v175
    v_cvt_pk_bf16_f32 v194, v176, v177
    v_cvt_pk_bf16_f32 v195, v178, v179
    ds_write_b128 v149, v[192:195] offset:8192
    v_mul_f32 v180, s68, v180
    v_mul_f32 v181, s68, v181
    v_mfma_f32_16x16x32_bf16 v[244:247], v[112:115], v[24:27], 0
    v_mul_f32 v182, s68, v182
    v_mul_f32 v183, s68, v183
    v_mul_f32 v184, s68, v184
    v_mul_f32 v185, s68, v185
    v_mul_f32 v186, s68, v186
    v_mul_f32 v187, s68, v187
    v_cvt_pk_bf16_f32 v196, v180, v181
    v_mfma_f32_16x16x32_bf16 v[248:251], v[116:119], v[24:27], 0
    v_cvt_pk_bf16_f32 v197, v182, v183
    v_cvt_pk_bf16_f32 v198, v184, v185
    v_cvt_pk_bf16_f32 v199, v186, v187
    ds_write_b128 v149, v[196:199] offset:16384
K_e8:
    s_waitcnt vmcnt(12) lgkmcnt(0)
    s_barrier
    s_cbranch_vccnz K_d9
    v_mfma_f32_16x16x32_bf16 v[228:231], v[120:123], v[28:31], v[228:231]
    ds_read_b64_tr_b16 v[112:113], v220 offset:0
    ds_read_b64_tr_b16 v[114:115], v220 offset:2048
    s_add_u32 m0, s63, 65536
    s_mov_b32 s11, 98304
    buffer_load_dwordx4 v212, s[92:95], s11 offen offset:0 lds
    v_mfma_f32_16x16x32_bf16 v[232:235], v[124:127], v[28:31], v[232:235]
    ds_read_b64_tr_b16 v[116:117], v220 offset:8
    ds_read_b64_tr_b16 v[118:119], v220 offset:2056
    buffer_load_dwordx4 v213, s[92:95], s11 offen offset:1024 lds
    v_mfma_f32_16x16x32_bf16 v[236:239], v[120:123], v[32:35], v[236:239]
    buffer_load_dwordx4 v212, s[92:95], s11 offen offset:2048 lds
    v_mfma_f32_16x16x32_bf16 v[240:243], v[124:127], v[32:35], v[240:243]
    buffer_load_dwordx4 v213, s[92:95], s11 offen offset:3072 lds
    v_mfma_f32_16x16x32_bf16 v[244:247], v[120:123], v[36:39], v[244:247]
    v_mfma_f32_16x16x32_bf16 v[248:251], v[124:127], v[36:39], v[248:251]
    s_branch K_e9
K_d9:
    v_mfma_f32_16x16x32_bf16 v[228:231], v[120:123], v[28:31], v[228:231]
    ds_read_b64_tr_b16 v[112:113], v220 offset:0
    ds_read_b64_tr_b16 v[114:115], v220 offset:2048
    v_mfma_f32_16x16x32_bf16 v[232:235], v[124:127], v[28:31], v[232:235]
    ds_read_b64_tr_b16 v[116:117], v220 offset:8
    ds_read_b64_tr_b16 v[118:119], v220 offset:2056
    ds_read_b128 v[188:191], v223 offset:0
    ds_read_b128 v[192:195], v223 offset:4096
    ds_read_b128 v[196:199], v223 offset:8192
    ds_read_b128 v[200:203], v223 offset:12288
    ds_read_b128 v[204:207], v223 offset:16384
    ds_read_b128 v[208:211], v223 offset:20480
    v_mfma_f32_16x16x32_bf16 v[236:239], v[120:123], v[32:35], v[236:239]
    v_mfma_f32_16x16x32_bf16 v[240:243], v[124:127], v[32:35], v[240:243]
    s_waitcnt lgkmcnt(5)
    buffer_store_dwordx4 v[188:191], v214, s[24:27], s7 offen sc0 sc1
    v_mfma_f32_16x16x32_bf16 v[244:247], v[120:123], v[36:39], v[244:247]
    s_waitcnt lgkmcnt(4)
    buffer_store_dwordx4 v[192:195], v215, s[24:27], s7 offen sc0 sc1
    v_mfma_f32_16x16x32_bf16 v[248:251], v[124:127], v[36:39], v[248:251]
    s_waitcnt lgkmcnt(3)
    buffer_store_dwordx4 v[196:199], v216, s[24:27], s7 offen sc0 sc1
    s_waitcnt lgkmcnt(2)
    buffer_store_dwordx4 v[200:203], v217, s[24:27], s7 offen sc0 sc1
    s_waitcnt lgkmcnt(1)
    buffer_store_dwordx4 v[204:207], v218, s[24:27], s7 offen sc0 sc1
    s_waitcnt lgkmcnt(0)
    buffer_store_dwordx4 v[208:211], v219, s[24:27], s7 offen sc0 sc1
K_e9:
    s_branch K_q
K_notp:
    s_mov_b32 s44, s76
    s_mov_b32 s45, s77
    s_mov_b32 s46, 0x9c400
    s_mov_b32 s47, 0x20000
    s_mov_b32 s48, s78
    s_mov_b32 s49, s79
    s_mov_b32 s50, 0x9c400
    s_mov_b32 s51, 0x20000
    v_lshlrev_b32 v16, 4, v0
    s_cmp_ge_u32 s2, 247
    s_cbranch_scc1 K_frag
    s_sub_u32 s7, s2, 215
    s_mul_i32 s62, s7, 20000
    s_cmp_lg_u32 s3, 7
    s_cbranch_scc1 K_nclr
    s_mul_i32 s4, s7, 7
    s_sub_u32 s4, s4, 1
    v_add_u32 v17, s4, v9
    v_add_u32 v18, 32, v17
    v_cmp_gt_u32 vcc, 215, v17
    v_cndmask_b32 v17, v18, v17, vcc
    v_writelane_b32 v17, s2, 0
    s_mov_b32 s4, 7864320
    v_lshlrev_b32 v17, 7, v17
    s_mov_b64 exec, 0xff
    buffer_store_dword v225, v17, s[28:31], s4 offen sc0 sc1
    s_mov_b64 exec, -1
K_nclr:
    s_add_u32 s11, s62, 0
    buffer_load_dwordx4 v[48:51], v16, s[48:51], s11 offen
    s_add_u32 s11, s62, 8192
    buffer_load_dwordx4 v[52:55], v16, s[48:51], s11 offen
    s_add_u32 s11, s62, 16384
    buffer_load_dwordx4 v[56:59], v16, s[48:51], s11 offen
    s_add_u32 s11, s62, 0
    buffer_load_dwordx4 v[60:63], v16, s[44:47], s11 offen
    s_add_u32 s11, s62, 8192
    buffer_load_dwordx4 v[64:67], v16, s[44:47], s11 offen
    s_add_u32 s11, s62, 16384
    buffer_load_dwordx4 v[68:71], v16, s[44:47], s11 offen
    v_lshrrev_b32 v19, 3, v0
    v_and_b32 v28, 7, v0
    v_lshlrev_b32 v29, 4, v28
    v_mul_u32_u24 v19, 4224, v19
    v_add_u32 v130, v19, v29
    s_lshl_b32 s7, s7, 7
    s_add_u32 s7, s7, 5242880
    v_mov_b32 v20, -1
    v_mov_b32 v21, -1
    v_mov_b32 v22, -1
    v_mov_b32 v23, -1
    ds_write_b128 v16, v[20:23] offset:2048
    ds_write_b128 v16, v[20:23] offset:10240
    ds_write_b128 v16, v[20:23] offset:18432
    ds_write_b128 v16, v[20:23] offset:26624
    ds_write_b128 v16, v[20:23] offset:34816
    ds_write_b128 v16, v[20:23] offset:43008
    ds_write_b128 v16, v[20:23] offset:51200
    ds_write_b128 v16, v[20:23] offset:59392
    v_lshlrev_b32 v17, 2, v0
    ds_write_b32 v17, v225
    v_lshlrev_b32 v17, 21, v0
    v_add_u32 v96, 0x0, v17
    v_add_u32 v97, 0x80000, v17
    v_add_u32 v98, 0x100000, v17
    v_add_u32 v99, 0x180000, v17
    v_add_u32 v100, 0x40000000, v17
    v_add_u32 v101, 0x40080000, v17
    v_add_u32 v102, 0x40100000, v17
    v_add_u32 v103, 0x40180000, v17
    v_add_u32 v104, 0x80000000, v17
    v_add_u32 v105, 0x80080000, v17
    v_add_u32 v106, 0x80100000, v17
    v_add_u32 v107, 0x80180000, v17
    s_movk_i32 s11, 226
    v_cmp_gt_u32 s[96:97], s11, v0
    v_mov_b32 v18, 33
    v_lshrrev_b32 v19, 3, v9
    s_lshl_b32 s11, s3, 3
    v_lshl_add_u32 v19, v19, 6, v28
    v_add_lshl_u32 v19, v19, s11, 2
    s_mov_b32 s88, s86
    s_mov_b32 s89, s87
    s_mov_b32 s90, 0x100
    s_mov_b32 s91, 0x20000
    s_mov_b32 s36, s84
    s_mov_b32 s37, s85
    s_mov_b32 s38, 0x4e2000
    s_mov_b32 s39, 0x20000
    s_waitcnt lgkmcnt(0)
    s_barrier
    s_waitcnt vmcnt(5)
    s_cmp_lg_u32 s3, 7
    s_cbranch_scc1 K_ncnt
    s_and_b32 s62, s2, 3
    s_lshl_b32 s62, s62, 6
    s_mov_b64 exec, 1
    buffer_atomic_add v226, v225, s[88:91], s62 offen sc1
    s_mov_b64 exec, -1
K_ncnt:
    v_lshlrev_b32 v72, 2, v48
    v_and_b32 v72, 0x7fc, v72
    ds_add_rtn_u32 v84, v72, v18
    v_lshlrev_b32 v73, 2, v49
    v_and_b32 v73, 0x7fc, v73
    ds_add_rtn_u32 v85, v73, v18
    v_lshlrev_b32 v74, 2, v50
    v_and_b32 v74, 0x7fc, v74
    ds_add_rtn_u32 v86, v74, v18
    v_lshlrev_b32 v75, 2, v51
    v_and_b32 v75, 0x7fc, v75
    ds_add_rtn_u32 v87, v75, v18
    s_waitcnt vmcnt(4)
    v_lshlrev_b32 v76, 2, v52
    v_and_b32 v76, 0x7fc, v76
    ds_add_rtn_u32 v88, v76, v18
    v_lshlrev_b32 v77, 2, v53
    v_and_b32 v77, 0x7fc, v77
    ds_add_rtn_u32 v89, v77, v18
    v_lshlrev_b32 v78, 2, v54
    v_and_b32 v78, 0x7fc, v78
    ds_add_rtn_u32 v90, v78, v18
    v_lshlrev_b32 v79, 2, v55
    v_and_b32 v79, 0x7fc, v79
    ds_add_rtn_u32 v91, v79, v18
    s_waitcnt vmcnt(3)
    s_mov_b64 exec, s[96:97]
    s_cbranch_execz K_p1
    v_lshlrev_b32 v80, 2, v56
    v_and_b32 v80, 0x7fc, v80
    ds_add_rtn_u32 v92, v80, v18
    v_lshlrev_b32 v81, 2, v57
    v_and_b32 v81, 0x7fc, v81
    ds_add_rtn_u32 v93, v81, v18
    v_lshlrev_b32 v82, 2, v58
    v_and_b32 v82, 0x7fc, v82
    ds_add_rtn_u32 v94, v82, v18
    v_lshlrev_b32 v83, 2, v59
    v_and_b32 v83, 0x7fc, v83
    ds_add_rtn_u32 v95, v83, v18
K_p1:
    s_mov_b64 exec, -1
    v_lshrrev_b32 v48, 9, v48
    v_lshl_or_b32 v96, v48, 14, v96
    v_lshlrev_b32 v72, 5, v72
    v_lshrrev_b32 v49, 9, v49
    v_lshl_or_b32 v97, v49, 14, v97
    v_lshlrev_b32 v73, 5, v73
    v_lshrrev_b32 v50, 9, v50
    v_lshl_or_b32 v98, v50, 14, v98
    v_lshlrev_b32 v74, 5, v74
    v_lshrrev_b32 v51, 9, v51
    v_lshl_or_b32 v99, v51, 14, v99
    v_lshlrev_b32 v75, 5, v75
    v_lshrrev_b32 v52, 9, v52
    v_lshl_or_b32 v100, v52, 14, v100
    v_lshlrev_b32 v76, 5, v76
    v_lshrrev_b32 v53, 9, v53
    v_lshl_or_b32 v101, v53, 14, v101
    v_lshlrev_b32 v77, 5, v77
    v_lshrrev_b32 v54, 9, v54
    v_lshl_or_b32 v102, v54, 14, v102
    v_lshlrev_b32 v78, 5, v78
    v_lshrrev_b32 v55, 9, v55
    v_lshl_or_b32 v103, v55, 14, v103
    v_lshlrev_b32 v79, 5, v79
    v_lshrrev_b32 v56, 9, v56
    v_lshl_or_b32 v104, v56, 14, v104
    v_lshlrev_b32 v80, 5, v80
    v_lshrrev_b32 v57, 9, v57
    v_lshl_or_b32 v105, v57, 14, v105
    v_lshlrev_b32 v81, 5, v81
    v_lshrrev_b32 v58, 9, v58
    v_lshl_or_b32 v106, v58, 14, v106
    v_lshlrev_b32 v82, 5, v82
    v_lshrrev_b32 v59, 9, v59
    v_lshl_or_b32 v107, v59, 14, v107
    v_lshlrev_b32 v83, 5, v83
    s_cmp_eq_u32 s3, 7
    s_cbranch_scc1 K_s7
    s_waitcnt vmcnt(0)
K_s7:
    s_waitcnt vmcnt(1) lgkmcnt(0)
    s_cmp_lg_u32 s16, 0
    s_cbranch_scc1 K_gxc
    s_add_u32 m0, s8, 134144
    s_nop 0
    buffer_load_dwordx4 v214, s[40:43], s9 offen lds
    s_add_u32 m0, s8, 138240
    s_nop 0
    buffer_load_dwordx4 v215, s[40:43], s9 offen lds
    s_add_u32 m0, s8, 142336
    s_nop 0
    buffer_load_dwordx4 v216, s[40:43], s9 offen lds
    s_add_u32 m0, s8, 146432
    s_nop 0
    buffer_load_dwordx4 v217, s[40:43], s9 offen lds
    s_add_u32 m0, s8, 150528
    s_nop 0
    buffer_load_dwordx4 v218, s[40:43], s9 offen lds
    s_add_u32 m0, s8, 154624
    s_nop 0
    buffer_load_dwordx4 v219, s[40:43], s9 offen lds
K_gxc:
    v_bfe_u32 v84, v84, 3, 5
    v_or_b32 v96, v96, v60
    v_lshl_add_u32 v84, v84, 2, v72
    ds_write_b32 v84, v96 offset:2048
    v_bfe_u32 v85, v85, 3, 5
    v_or_b32 v97, v97, v61
    v_lshl_add_u32 v85, v85, 2, v73
    ds_write_b32 v85, v97 offset:2048
    v_bfe_u32 v86, v86, 3, 5
    v_or_b32 v98, v98, v62
    v_lshl_add_u32 v86, v86, 2, v74
    ds_write_b32 v86, v98 offset:2048
    v_bfe_u32 v87, v87, 3, 5
    v_or_b32 v99, v99, v63
    v_lshl_add_u32 v87, v87, 2, v75
    ds_write_b32 v87, v99 offset:2048
    v_bfe_u32 v88, v88, 3, 5
    v_or_b32 v100, v100, v64
    v_lshl_add_u32 v88, v88, 2, v76
    ds_write_b32 v88, v100 offset:2048
    v_bfe_u32 v89, v89, 3, 5
    v_or_b32 v101, v101, v65
    v_lshl_add_u32 v89, v89, 2, v77
    ds_write_b32 v89, v101 offset:2048
    v_bfe_u32 v90, v90, 3, 5
    v_or_b32 v102, v102, v66
    v_lshl_add_u32 v90, v90, 2, v78
    ds_write_b32 v90, v102 offset:2048
    v_bfe_u32 v91, v91, 3, 5
    v_or_b32 v103, v103, v67
    v_lshl_add_u32 v91, v91, 2, v79
    ds_write_b32 v91, v103 offset:2048
    s_mov_b64 exec, s[96:97]
    s_cbranch_execz K_p2
    v_bfe_u32 v92, v92, 3, 5
    v_or_b32 v104, v104, v68
    v_lshl_add_u32 v92, v92, 2, v80
    ds_write_b32 v92, v104 offset:2048
    v_bfe_u32 v93, v93, 3, 5
    v_or_b32 v105, v105, v69
    v_lshl_add_u32 v93, v93, 2, v81
    ds_write_b32 v93, v105 offset:2048
    v_bfe_u32 v94, v94, 3, 5
    v_or_b32 v106, v106, v70
    v_lshl_add_u32 v94, v94, 2, v82
    ds_write_b32 v94, v106 offset:2048
    v_bfe_u32 v95, v95, 3, 5
    v_or_b32 v107, v107, v71
    v_lshl_add_u32 v95, v95, 2, v83
    ds_write_b32 v95, v107 offset:2048
K_p2:
    s_mov_b64 exec, -1
    s_movk_i32 s11, 1056
    s_waitcnt lgkmcnt(0)
    s_barrier
    ds_read_b32 v17, v19
    s_waitcnt lgkmcnt(0)
    v_cmp_lt_u32 vcc, s11, v17
    s_cbranch_vccz K_p4
    v_mov_b32 v24, -2
    v_mov_b32 v25, -2
    v_mov_b32 v26, -2
    v_mov_b32 v27, -2
    v_lshlrev_b32 v19, 5, v19
    s_mov_b64 exec, vcc
    ds_write_b128 v19, v[24:27] offset:2048
    ds_write_b128 v19, v[24:27] offset:2064
    ds_write_b128 v19, v[24:27] offset:2080
    ds_write_b128 v19, v[24:27] offset:2096
    ds_write_b128 v19, v[24:27] offset:2112
    ds_write_b128 v19, v[24:27] offset:2128
    ds_write_b128 v19, v[24:27] offset:2144
    ds_write_b128 v19, v[24:27] offset:2160
    s_mov_b64 exec, -1
K_p4:
    ds_read_b128 v[164:167], v16 offset:2048
    ds_read_b128 v[168:171], v16 offset:10240
    ds_read_b128 v[172:175], v16 offset:18432
    ds_read_b128 v[176:179], v16 offset:26624
    ds_read_b128 v[180:183], v16 offset:34816
    ds_read_b128 v[184:187], v16 offset:43008
    ds_read_b128 v[188:191], v16 offset:51200
    ds_read_b128 v[192:195], v16 offset:59392
    s_waitcnt lgkmcnt(7)
    buffer_store_dwordx4 v[164:167], v130, s[28:31], s7 offen sc0 sc1
    s_add_u32 s7, s7, 270336
    s_waitcnt lgkmcnt(6)
    buffer_store_dwordx4 v[168:171], v130, s[28:31], s7 offen sc0 sc1
    s_add_u32 s7, s7, 270336
    s_waitcnt lgkmcnt(5)
    buffer_store_dwordx4 v[172:175], v130, s[28:31], s7 offen sc0 sc1
    s_add_u32 s7, s7, 270336
    s_waitcnt lgkmcnt(4)
    buffer_store_dwordx4 v[176:179], v130, s[28:31], s7 offen sc0 sc1
    s_add_u32 s7, s7, 270336
    s_waitcnt lgkmcnt(3)
    buffer_store_dwordx4 v[180:183], v130, s[28:31], s7 offen sc0 sc1
    s_add_u32 s7, s7, 270336
    s_waitcnt lgkmcnt(2)
    buffer_store_dwordx4 v[184:187], v130, s[28:31], s7 offen sc0 sc1
    s_add_u32 s7, s7, 270336
    s_waitcnt lgkmcnt(1)
    buffer_store_dwordx4 v[188:191], v130, s[28:31], s7 offen sc0 sc1
    s_add_u32 s7, s7, 270336
    s_waitcnt lgkmcnt(0)
    buffer_store_dwordx4 v[192:195], v130, s[28:31], s7 offen sc0 sc1
    s_barrier
    s_cmp_lg_u32 s16, 1
    s_cbranch_scc1 K_gwc
    s_add_u32 m0, s63, 49152
    s_mov_b32 s11, 0
    buffer_load_dwordx4 v212, s[92:95], s11 offen offset:0 lds
    buffer_load_dwordx4 v213, s[92:95], s11 offen offset:1024 lds
    buffer_load_dwordx4 v212, s[92:95], s11 offen offset:2048 lds
    buffer_load_dwordx4 v213, s[92:95], s11 offen offset:3072 lds
    s_add_u32 m0, s63, 65536
    s_mov_b32 s11, 16384
    buffer_load_dwordx4 v212, s[92:95], s11 offen offset:0 lds
    buffer_load_dwordx4 v213, s[92:95], s11 offen offset:1024 lds
    buffer_load_dwordx4 v212, s[92:95], s11 offen offset:2048 lds
    buffer_load_dwordx4 v213, s[92:95], s11 offen offset:3072 lds
K_gwc:
    s_mov_b32 s32, s74
    s_mov_b32 s33, s75
    s_mov_b32 s34, 0x0
    s_mov_b32 s35, 0x20000
    s_or_b32 s33, s33, 2097152
    s_mov_b32 s24, s28
    s_mov_b32 s25, s29
    s_mov_b32 s26, 0x4e3000
    s_mov_b32 s27, 0x20000
    s_mul_i32 s15, s16, 23296
    s_add_u32 s15, s15, 84992
    s_lshl_b32 s11, s17, 7
    s_add_u32 s20, s11, 4096
    s_add_u32 s21, s11, 3008
    s_add_u32 s22, s11, 1920
    s_add_u32 s23, s11, 832
    s_lshl_b32 s19, s16, 8
    s_add_u32 s19, s19, s2
    s_mul_i32 s14, s19, 4224
    s_add_u32 s14, s14, 5242880
    s_mov_b32 s54, 0
    s_mov_b32 s58, -1
    s_mov_b32 s13, 1
    s_mov_b32 s12, 0
    v_and_b32 v7, 0xff, v0
    v_lshlrev_b32 v7, 4, v7
    v_bfe_u32 v255, v0, 3, 5
    v_mul_u32_u24 v255, 5000, v255
    v_mov_b32 v228, 0
    v_mov_b32 v229, 0
    v_mov_b32 v230, 0
    v_mov_b32 v231, 0
    v_lshlrev_b32 v232, 4, v0
    v_add_u32 v232, 84992, v232
    ds_write_b128 v232, v[228:231] offset:0
    ds_write_b128 v232, v[228:231] offset:8192
    ds_write_b128 v232, v[228:231] offset:16384
    ds_write_b128 v232, v[228:231] offset:24576
    ds_write_b128 v232, v[228:231] offset:32768
    ds_write_b128 v232, v[228:231] offset:40960
    v_mul_u32_u24 v228, 6656, v254
    v_and_b32 v229, 31, v9
    v_lshl_add_u32 v228, v229, 4, v228
    v_add_u32 v1, s15, v228
    s_add_u32 s61, s15, 19968
    v_lshrrev_b32 v228, 3, v9
    v_lshl_add_u32 v3, v228, 4, s61
    v_lshrrev_b32 v228, 1, v9
    v_lshl_add_u32 v6, v228, 2, s61
    v_add_u32 v6, 1664, v6
    v_bfe_u32 v228, v9, 4, 1
    v_bfe_u32 v229, v9, 1, 1
    v_lshl_add_u32 v228, v228, 1, v229
    v_mul_u32_u24 v228, 6656, v228
    v_bfe_u32 v229, v9, 2, 2
    v_lshl_add_u32 v229, v254, 2, v229
    v_lshl_add_u32 v228, v229, 4, v228
    v_and_b32 v229, 1, v9
    v_lshl_add_u32 v228, v229, 3, v228
    v_add_u32 v2, s15, v228
    v_lshrrev_b32 v240, 4, v9
    v_bfe_u32 v241, v9, 2, 2
    v_and_b32 v242, 15, v9
    v_bfe_u32 v228, v9, 3, 2
    v_xor_b32 v228, v228, v9
    v_and_b32 v228, 7, v228
    v_lshlrev_b32 v10, 4, v228
    v_xor_b32 v228, v240, v9
    v_and_b32 v228, 1, v228
    v_lshlrev_b32 v15, 4, v228
    v_lshlrev_b32 v228, 3, v254
    v_sub_u32 v228, v253, v228
    v_and_b32 v229, 1, v228
    v_lshlrev_b32 v229, 4, v229
    v_mov_b32 v230, 0x3f80
    v_lshlrev_b32 v229, v229, v230
    v_ashrrev_i32 v228, 1, v228
    v_cmp_eq_u32 vcc, 0, v228
    v_cndmask_b32 v156, 0, v229, vcc
    v_cmp_eq_u32 vcc, 1, v228
    v_cndmask_b32 v157, 0, v229, vcc
    v_cmp_eq_u32 vcc, 2, v228
    v_cndmask_b32 v158, 0, v229, vcc
    v_cmp_eq_u32 vcc, 3, v228
    v_cndmask_b32 v159, 0, v229, vcc
    v_cmp_eq_u32 vcc, 8, v228
    v_cndmask_b32 v160, 0, v229, vcc
    v_cmp_eq_u32 vcc, 9, v228
    v_cndmask_b32 v161, 0, v229, vcc
    v_cmp_eq_u32 vcc, 10, v228
    v_cndmask_b32 v162, 0, v229, vcc
    v_cmp_eq_u32 vcc, 11, v228
    v_cndmask_b32 v163, 0, v229, vcc
    v_xor_b32 v228, v241, v254
    v_lshlrev_b32 v228, 4, v228
    v_lshrrev_b32 v229, 2, v253
    v_lshl_add_u32 v228, v229, 7, v228
    v_mul_u32_u24 v229, 68, v117
    v_add_u32 v228, v228, v229
    v_add_u32 v4, s18, v228
    v_xor_b32 v5, 32, v4
    v_bfe_u32 v228, v9, 3, 1
    v_xor_b32 v228, v228, v254
    v_lshlrev_b32 v228, 4, v228
    v_lshl_add_u32 v228, v253, 5, v228
    v_add_u32 v8, s18, v228
    v_lshl_add_u32 v228, v240, 3, v241
    v_lshl_add_u32 v228, v228, 9, v117
    v_xor_b32 v229, s3, v241
    v_lshl_add_u32 v220, v229, 6, v228
    v_add_u32 v148, 0x10000, v220
    v_xor_b32 v228, v240, v242
    v_lshlrev_b32 v228, 4, v228
    v_lshl_add_u32 v228, v242, 9, v228
    v_add_u32 v221, 134144, v228
    v_xor_b32 v149, s6, v221
    v_lshl_add_u32 v228, v116, 18, v117
    v_add_u32 v229, 0x400000, v228
    v_subrev_u32 v243, 0xe0000, v228
    v_cmp_le_u32 vcc, 4, v116
    v_add_u32 v230, 0x320000, v228
    v_cndmask_b32 v229, v229, v243, vcc
    v_and_b32 v243, 7, v253
    v_xor_b32 v243, v243, v254
    v_lshlrev_b32 v243, 4, v243
    v_lshl_add_u32 v231, v253, 7, v243
    v_cmp_le_u32 vcc, 4, v242
    v_add_u32 v243, 16, v242
    v_subrev_u32 v244, 4, v242
    v_cndmask_b32 v243, v243, v244, vcc
    v_mov_b32 v245, 42496
    v_cndmask_b32 v244, 0, v245, vcc
    v_add_u32 v246, 12, v242
    v_and_b32 v247, 7, v242
    v_xor_b32 v247, v247, v240
    v_lshlrev_b32 v247, 4, v247
    v_lshl_add_u32 v247, v242, 7, v247
    v_add_u32 v232, 0, v247
    v_xor_b32 v236, 64, v232
    v_and_b32 v247, 7, v243
    v_xor_b32 v247, v247, v240
    v_lshlrev_b32 v247, 4, v247
    v_lshl_add_u32 v247, v243, 7, v247
    v_add_u32 v233, v244, v247
    v_xor_b32 v237, 64, v233
    v_and_b32 v247, 7, v246
    v_xor_b32 v247, v247, v240
    v_lshlrev_b32 v247, 4, v247
    v_lshl_add_u32 v247, v246, 7, v247
    v_add_u32 v234, v245, v247
    v_xor_b32 v238, 64, v234
    v_lshlrev_b32 v243, 6, v242
    v_lshl_add_u32 v235, v240, 4, v243
    v_add_u32 v243, 158720, v252
    ds_write_b128 v243, v[228:231] offset:0
    ds_write_b128 v243, v[232:235] offset:1024
    ds_write_b128 v243, v[236:239] offset:2048
    s_mul_i32 s11, s3, 3072
    s_add_u32 s11, s11, 134144
    v_add_u32 v150, s11, v235
    s_add_u32 s11, s8, 134144
    v_add_u32 v223, s11, v252
    s_mul_i32 s11, s17, 6144
    s_mul_i32 s61, s16, 1280
    s_add_u32 s11, s11, s61
    s_add_u32 s11, s11, 134144
    v_lshl_add_u32 v243, v254, 3, v241
    v_and_b32 v244, 1, v240
    v_lshl_add_u32 v243, v243, 1, v244
    v_lshrrev_b32 v244, 1, v117
    v_lshl_add_u32 v243, v243, 5, v244
    v_add_u32 v151, s11, v243
    v_mov_b32 v136, 0
    v_mov_b32 v137, 0
    v_mov_b32 v138, 0
    v_mov_b32 v139, 0
    v_mov_b32 v144, 0
    v_mov_b32 v145, 0
    v_mov_b32 v146, 0
    v_mov_b32 v147, 0
    s_lshl_b32 s11, s3, 5
    v_add_u32 v152, s11, v253
    v_lshlrev_b32 v152, 7, v152
    s_mov_b32 s68, 0xbfb8aa3b
    s_mov_b32 s69, s68
    s_cmp_lg_u32 s16, 0
    s_cbranch_scc1 K_gc0
    s_waitcnt vmcnt(8)
K_gc0:
    s_barrier
    ds_read_b128 v[16:19], v221 offset:0
    ds_read_b128 v[20:23], v221 offset:8192
    ds_read_b128 v[24:27], v221 offset:16384
    v_xor_b32 v129, 64, v221
    ds_read_b128 v[28:31], v129 offset:0
    ds_read_b128 v[32:35], v129 offset:8192
    ds_read_b128 v[36:39], v129 offset:16384
    v_xor_b32 v128, 128, v221
    ds_read_b128 v[40:43], v128 offset:0
    ds_read_b128 v[44:47], v128 offset:8192
    ds_read_b128 v[48:51], v128 offset:16384
    v_xor_b32 v129, 192, v221
    ds_read_b128 v[52:55], v129 offset:0
    ds_read_b128 v[56:59], v129 offset:8192
    ds_read_b128 v[60:63], v129 offset:16384
    s_waitcnt lgkmcnt(3)
    v_xor_b32 v128, 256, v221
    ds_read_b128 v[64:67], v128 offset:0
    ds_read_b128 v[68:71], v128 offset:8192
    ds_read_b128 v[72:75], v128 offset:16384
    v_xor_b32 v129, 320, v221
    ds_read_b128 v[76:79], v129 offset:0
    ds_read_b128 v[80:83], v129 offset:8192
    ds_read_b128 v[84:87], v129 offset:16384
    v_xor_b32 v128, 384, v221
    ds_read_b128 v[88:91], v128 offset:0
    ds_read_b128 v[92:95], v128 offset:8192
    ds_read_b128 v[96:99], v128 offset:16384
    v_xor_b32 v129, 448, v221
    ds_read_b128 v[100:103], v129 offset:0
    ds_read_b128 v[104:107], v129 offset:8192
    ds_read_b128 v[108:111], v129 offset:16384
    s_waitcnt lgkmcnt(3)
    s_cmp_lg_u32 s16, 0
    s_cbranch_scc1 K_gc1
    s_waitcnt vmcnt(0)
K_gc1:
    s_waitcnt vmcnt(4)
    s_barrier
    s_cmp_lg_u32 s3, 0
    s_cbranch_scc1 K_nflc
    s_mov_b64 exec, 1
    buffer_store_dword v226, v225, s[28:31], s10 offen sc0 sc1
    s_mov_b64 exec, -1
K_nflc:
    s_cmp_lg_u32 s16, 1
    s_cbranch_scc1 K_gwd
    s_add_u32 m0, s63, 0
    s_mov_b32 s11, 32768
    buffer_load_dwordx4 v212, s[92:95], s11 offen offset:0 lds
    buffer_load_dwordx4 v213, s[92:95], s11 offen offset:1024 lds
    buffer_load_dwordx4 v212, s[92:95], s11 offen offset:2048 lds
    buffer_load_dwordx4 v213, s[92:95], s11 offen offset:3072 lds
    s_add_u32 m0, s63, 16384
    s_mov_b32 s11, 49152
    buffer_load_dwordx4 v212, s[92:95], s11 offen offset:0 lds
    buffer_load_dwordx4 v213, s[92:95], s11 offen offset:1024 lds
    buffer_load_dwordx4 v212, s[92:95], s11 offen offset:2048 lds
    buffer_load_dwordx4 v213, s[92:95], s11 offen offset:3072 lds
    s_add_u32 m0, s63, 32768
    s_mov_b32 s11, 65536
    buffer_load_dwordx4 v212, s[92:95], s11 offen offset:0 lds
    buffer_load_dwordx4 v213, s[92:95], s11 offen offset:1024 lds
    buffer_load_dwordx4 v212, s[92:95], s11 offen offset:2048 lds
    buffer_load_dwordx4 v213, s[92:95], s11 offen offset:3072 lds
K_gwd:
    s_branch K_sig2
K_frag:
    s_cmp_lg_u32 s16, 0
    s_cbranch_scc1 K_gxf
    s_add_u32 m0, s8, 134144
    s_nop 0
    buffer_load_dwordx4 v214, s[40:43], s9 offen lds
    s_add_u32 m0, s8, 138240
    s_nop 0
    buffer_load_dwordx4 v215, s[40:43], s9 offen lds
    s_add_u32 m0, s8, 142336
    s_nop 0
    buffer_load_dwordx4 v216, s[40:43], s9 offen lds
    s_add_u32 m0, s8, 146432
    s_nop 0
    buffer_load_dwordx4 v217, s[40:43], s9 offen lds
    s_add_u32 m0, s8, 150528
    s_nop 0
    buffer_load_dwordx4 v218, s[40:43], s9 offen lds
    s_add_u32 m0, s8, 154624
    s_nop 0
    buffer_load_dwordx4 v219, s[40:43], s9 offen lds
K_gxf:
    s_sub_u32 s7, s2, 247
    v_bfe_u32 v17, v9, 2, 2
    v_bfe_u32 v18, v9, 4, 1
    s_lshl_b32 s62, s7, 14
    s_cmp_eq_u32 s7, 8
    s_cselect_b32 s40, s80, s82
    s_cselect_b32 s41, s81, s83
    s_cselect_b32 s42, s66, s94
    s_add_u32 m0, s8, 0
    s_add_u32 s11, s62, 131072
    buffer_load_dwordx4 v16, s[40:43], s11 offen lds
    s_add_u32 m0, s8, 8192
    s_add_u32 s11, s62, 139264
    buffer_load_dwordx4 v16, s[40:43], s11 offen lds
    s_mov_b32 s88, s86
    s_mov_b32 s89, s87
    s_mov_b32 s90, 0x100
    s_mov_b32 s91, 0x20000
    s_mov_b32 s36, s84
    s_mov_b32 s37, s85
    s_mov_b32 s38, 0x4e2000
    s_mov_b32 s39, 0x20000
    s_mov_b32 s32, s74
    s_mov_b32 s33, s75
    s_mov_b32 s34, 0x0
    s_mov_b32 s35, 0x20000
    s_or_b32 s33, s33, 2097152
    s_mov_b32 s24, s28
    s_mov_b32 s25, s29
    s_mov_b32 s26, 0x4e3000
    s_mov_b32 s27, 0x20000
    s_mul_i32 s15, s16, 23296
    s_add_u32 s15, s15, 84992
    s_lshl_b32 s11, s17, 7
    s_add_u32 s20, s11, 4096
    s_add_u32 s21, s11, 3008
    s_add_u32 s22, s11, 1920
    s_add_u32 s23, s11, 832
    s_lshl_b32 s19, s16, 8
    s_add_u32 s19, s19, s2
    s_mul_i32 s14, s19, 4224
    s_add_u32 s14, s14, 5242880
    s_mov_b32 s54, 0
    s_mov_b32 s58, -1
    s_mov_b32 s13, 1
    s_mov_b32 s12, 0
    v_and_b32 v7, 0xff, v0
    v_lshlrev_b32 v7, 4, v7
    v_bfe_u32 v255, v0, 3, 5
    v_mul_u32_u24 v255, 5000, v255
    v_mov_b32 v228, 0
    v_mov_b32 v229, 0
    v_mov_b32 v230, 0
    v_mov_b32 v231, 0
    v_lshlrev_b32 v232, 4, v0
    v_add_u32 v232, 84992, v232
    ds_write_b128 v232, v[228:231] offset:0
    ds_write_b128 v232, v[228:231] offset:8192
    ds_write_b128 v232, v[228:231] offset:16384
    ds_write_b128 v232, v[228:231] offset:24576
    ds_write_b128 v232, v[228:231] offset:32768
    ds_write_b128 v232, v[228:231] offset:40960
    v_mul_u32_u24 v228, 6656, v254
    v_and_b32 v229, 31, v9
    v_lshl_add_u32 v228, v229, 4, v228
    v_add_u32 v1, s15, v228
    s_add_u32 s61, s15, 19968
    v_lshrrev_b32 v228, 3, v9
    v_lshl_add_u32 v3, v228, 4, s61
    v_lshrrev_b32 v228, 1, v9
    v_lshl_add_u32 v6, v228, 2, s61
    v_add_u32 v6, 1664, v6
    v_bfe_u32 v228, v9, 4, 1
    v_bfe_u32 v229, v9, 1, 1
    v_lshl_add_u32 v228, v228, 1, v229
    v_mul_u32_u24 v228, 6656, v228
    v_bfe_u32 v229, v9, 2, 2
    v_lshl_add_u32 v229, v254, 2, v229
    v_lshl_add_u32 v228, v229, 4, v228
    v_and_b32 v229, 1, v9
    v_lshl_add_u32 v228, v229, 3, v228
    v_add_u32 v2, s15, v228
    v_lshrrev_b32 v240, 4, v9
    v_bfe_u32 v241, v9, 2, 2
    v_and_b32 v242, 15, v9
    v_bfe_u32 v228, v9, 3, 2
    v_xor_b32 v228, v228, v9
    v_and_b32 v228, 7, v228
    v_lshlrev_b32 v10, 4, v228
    v_xor_b32 v228, v240, v9
    v_and_b32 v228, 1, v228
    v_lshlrev_b32 v15, 4, v228
    v_lshlrev_b32 v228, 3, v254
    v_sub_u32 v228, v253, v228
    v_and_b32 v229, 1, v228
    v_lshlrev_b32 v229, 4, v229
    v_mov_b32 v230, 0x3f80
    v_lshlrev_b32 v229, v229, v230
    v_ashrrev_i32 v228, 1, v228
    v_cmp_eq_u32 vcc, 0, v228
    v_cndmask_b32 v156, 0, v229, vcc
    v_cmp_eq_u32 vcc, 1, v228
    v_cndmask_b32 v157, 0, v229, vcc
    v_cmp_eq_u32 vcc, 2, v228
    v_cndmask_b32 v158, 0, v229, vcc
    v_cmp_eq_u32 vcc, 3, v228
    v_cndmask_b32 v159, 0, v229, vcc
    v_cmp_eq_u32 vcc, 8, v228
    v_cndmask_b32 v160, 0, v229, vcc
    v_cmp_eq_u32 vcc, 9, v228
    v_cndmask_b32 v161, 0, v229, vcc
    v_cmp_eq_u32 vcc, 10, v228
    v_cndmask_b32 v162, 0, v229, vcc
    v_cmp_eq_u32 vcc, 11, v228
    v_cndmask_b32 v163, 0, v229, vcc
    v_xor_b32 v228, v241, v254
    v_lshlrev_b32 v228, 4, v228
    v_lshrrev_b32 v229, 2, v253
    v_lshl_add_u32 v228, v229, 7, v228
    v_mul_u32_u24 v229, 68, v117
    v_add_u32 v228, v228, v229
    v_add_u32 v4, s18, v228
    v_xor_b32 v5, 32, v4
    v_bfe_u32 v228, v9, 3, 1
    v_xor_b32 v228, v228, v254
    v_lshlrev_b32 v228, 4, v228
    v_lshl_add_u32 v228, v253, 5, v228
    v_add_u32 v8, s18, v228
    v_lshl_add_u32 v228, v240, 3, v241
    v_lshl_add_u32 v228, v228, 9, v117
    v_xor_b32 v229, s3, v241
    v_lshl_add_u32 v220, v229, 6, v228
    v_add_u32 v148, 0x10000, v220
    v_xor_b32 v228, v240, v242
    v_lshlrev_b32 v228, 4, v228
    v_lshl_add_u32 v228, v242, 9, v228
    v_add_u32 v221, 134144, v228
    v_xor_b32 v149, s6, v221
    v_lshl_add_u32 v228, v116, 18, v117
    v_add_u32 v229, 0x400000, v228
    v_subrev_u32 v243, 0xe0000, v228
    v_cmp_le_u32 vcc, 4, v116
    v_add_u32 v230, 0x320000, v228
    v_cndmask_b32 v229, v229, v243, vcc
    v_and_b32 v243, 7, v253
    v_xor_b32 v243, v243, v254
    v_lshlrev_b32 v243, 4, v243
    v_lshl_add_u32 v231, v253, 7, v243
    v_cmp_le_u32 vcc, 4, v242
    v_add_u32 v243, 16, v242
    v_subrev_u32 v244, 4, v242
    v_cndmask_b32 v243, v243, v244, vcc
    v_mov_b32 v245, 42496
    v_cndmask_b32 v244, 0, v245, vcc
    v_add_u32 v246, 12, v242
    v_and_b32 v247, 7, v242
    v_xor_b32 v247, v247, v240
    v_lshlrev_b32 v247, 4, v247
    v_lshl_add_u32 v247, v242, 7, v247
    v_add_u32 v232, 0, v247
    v_xor_b32 v236, 64, v232
    v_and_b32 v247, 7, v243
    v_xor_b32 v247, v247, v240
    v_lshlrev_b32 v247, 4, v247
    v_lshl_add_u32 v247, v243, 7, v247
    v_add_u32 v233, v244, v247
    v_xor_b32 v237, 64, v233
    v_and_b32 v247, 7, v246
    v_xor_b32 v247, v247, v240
    v_lshlrev_b32 v247, 4, v247
    v_lshl_add_u32 v247, v246, 7, v247
    v_add_u32 v234, v245, v247
    v_xor_b32 v238, 64, v234
    v_lshlrev_b32 v243, 6, v242
    v_lshl_add_u32 v235, v240, 4, v243
    v_add_u32 v243, 158720, v252
    ds_write_b128 v243, v[228:231] offset:0
    ds_write_b128 v243, v[232:235] offset:1024
    ds_write_b128 v243, v[236:239] offset:2048
    s_mul_i32 s11, s3, 3072
    s_add_u32 s11, s11, 134144
    v_add_u32 v150, s11, v235
    s_add_u32 s11, s8, 134144
    v_add_u32 v223, s11, v252
    s_mul_i32 s11, s17, 6144
    s_mul_i32 s61, s16, 1280
    s_add_u32 s11, s11, s61
    s_add_u32 s11, s11, 134144
    v_lshl_add_u32 v243, v254, 3, v241
    v_and_b32 v244, 1, v240
    v_lshl_add_u32 v243, v243, 1, v244
    v_lshrrev_b32 v244, 1, v117
    v_lshl_add_u32 v243, v243, 5, v244
    v_add_u32 v151, s11, v243
    v_mov_b32 v136, 0
    v_mov_b32 v137, 0
    v_mov_b32 v138, 0
    v_mov_b32 v139, 0
    v_mov_b32 v144, 0
    v_mov_b32 v145, 0
    v_mov_b32 v146, 0
    v_mov_b32 v147, 0
    s_lshl_b32 s11, s3, 5
    v_add_u32 v152, s11, v253
    v_lshlrev_b32 v152, 7, v152
    s_mov_b32 s68, 0xbfb8aa3b
    s_mov_b32 s69, s68
    s_waitcnt vmcnt(0)
    s_barrier
    s_cmp_eq_u32 s7, 8
    s_cbranch_scc1 K_w3
    v_lshl_add_u32 v19, v254, 4, v17
    v_lshl_add_u32 v21, v18, 3, v19
    v_lshl_add_u32 v19, v18, 2, v19
    v_add_u32 v20, s6, v117
    v_lshl_add_u32 v19, v19, 9, v20
    v_lshl_add_u32 v21, v21, 9, v20
    s_lshl_b32 s62, s3, 14
    s_lshl_b32 s7, s7, 11
    s_add_u32 s62, s62, s7
    s_add_u32 s62, s62, 7471104
    ds_read_b64_tr_b16 v[164:165], v19 offset:0
    ds_read_b64_tr_b16 v[166:167], v19 offset:4096
    ds_read_b64_tr_b16 v[168:169], v19 offset:8
    ds_read_b64_tr_b16 v[170:171], v19 offset:4104
    s_add_u32 s7, s62, 262144
    s_waitcnt lgkmcnt(0)
    buffer_store_dwordx4 v[164:167], v252, s[28:31], s62 offen offset:0 sc0 sc1
    buffer_store_dwordx4 v[168:171], v252, s[28:31], s62 offen offset:1024 sc0 sc1
    s_branch K_sig
K_w3:
    v_lshl_add_u32 v19, v254, 3, v17
    v_lshlrev_b32 v19, 9, v19
    v_lshl_add_u32 v19, v18, 5, v19
    v_lshrrev_b32 v20, 1, v117
    v_add3_u32 v19, v19, v20, s6
    s_add_u32 s62, s8, 7602176
    ds_read_b64_tr_b16 v[164:165], v19 offset:0
    ds_read_b64_tr_b16 v[166:167], v19 offset:2048
    s_waitcnt lgkmcnt(0)
    v_lshlrev_b32 v20, 16, v164
    v_and_b32 v21, 0xffff0000, v164
    v_mul_f32 v20, s68, v20
    v_mul_f32 v21, s68, v21
    v_cvt_pk_bf16_f32 v164, v20, v21
    v_lshlrev_b32 v20, 16, v165
    v_and_b32 v21, 0xffff0000, v165
    v_mul_f32 v20, s68, v20
    v_mul_f32 v21, s68, v21
    v_cvt_pk_bf16_f32 v165, v20, v21
    v_lshlrev_b32 v20, 16, v166
    v_and_b32 v21, 0xffff0000, v166
    v_mul_f32 v20, s68, v20
    v_mul_f32 v21, s68, v21
    v_cvt_pk_bf16_f32 v166, v20, v21
    v_lshlrev_b32 v20, 16, v167
    v_and_b32 v21, 0xffff0000, v167
    v_mul_f32 v20, s68, v20
    v_mul_f32 v21, s68, v21
    v_cvt_pk_bf16_f32 v167, v20, v21
    buffer_store_dwordx4 v[164:167], v252, s[28:31], s62 offen sc0 sc1
K_sig:
    s_barrier
    s_cmp_lg_u32 s16, 1
    s_cbranch_scc1 K_gwf
    s_add_u32 m0, s63, 49152
    s_mov_b32 s11, 0
    buffer_load_dwordx4 v212, s[92:95], s11 offen offset:0 lds
    buffer_load_dwordx4 v213, s[92:95], s11 offen offset:1024 lds
    buffer_load_dwordx4 v212, s[92:95], s11 offen offset:2048 lds
    buffer_load_dwordx4 v213, s[92:95], s11 offen offset:3072 lds
    s_add_u32 m0, s63, 65536
    s_mov_b32 s11, 16384
    buffer_load_dwordx4 v212, s[92:95], s11 offen offset:0 lds
    buffer_load_dwordx4 v213, s[92:95], s11 offen offset:1024 lds
    buffer_load_dwordx4 v212, s[92:95], s11 offen offset:2048 lds
    buffer_load_dwordx4 v213, s[92:95], s11 offen offset:3072 lds
    s_add_u32 m0, s63, 0
    s_mov_b32 s11, 32768
    buffer_load_dwordx4 v212, s[92:95], s11 offen offset:0 lds
    buffer_load_dwordx4 v213, s[92:95], s11 offen offset:1024 lds
    buffer_load_dwordx4 v212, s[92:95], s11 offen offset:2048 lds
    buffer_load_dwordx4 v213, s[92:95], s11 offen offset:3072 lds
    s_add_u32 m0, s63, 16384
    s_mov_b32 s11, 49152
    buffer_load_dwordx4 v212, s[92:95], s11 offen offset:0 lds
    buffer_load_dwordx4 v213, s[92:95], s11 offen offset:1024 lds
    buffer_load_dwordx4 v212, s[92:95], s11 offen offset:2048 lds
    buffer_load_dwordx4 v213, s[92:95], s11 offen offset:3072 lds
    s_add_u32 m0, s63, 32768
    s_mov_b32 s11, 65536
    buffer_load_dwordx4 v212, s[92:95], s11 offen offset:0 lds
    buffer_load_dwordx4 v213, s[92:95], s11 offen offset:1024 lds
    buffer_load_dwordx4 v212, s[92:95], s11 offen offset:2048 lds
    buffer_load_dwordx4 v213, s[92:95], s11 offen offset:3072 lds
K_gwf:
    ds_read_b128 v[16:19], v221 offset:0
    ds_read_b128 v[20:23], v221 offset:8192
    ds_read_b128 v[24:27], v221 offset:16384
    v_xor_b32 v129, 64, v221
    ds_read_b128 v[28:31], v129 offset:0
    ds_read_b128 v[32:35], v129 offset:8192
    ds_read_b128 v[36:39], v129 offset:16384
    v_xor_b32 v128, 128, v221
    ds_read_b128 v[40:43], v128 offset:0
    ds_read_b128 v[44:47], v128 offset:8192
    ds_read_b128 v[48:51], v128 offset:16384
    v_xor_b32 v129, 192, v221
    ds_read_b128 v[52:55], v129 offset:0
    ds_read_b128 v[56:59], v129 offset:8192
    ds_read_b128 v[60:63], v129 offset:16384
    s_waitcnt lgkmcnt(3)
    v_xor_b32 v128, 256, v221
    ds_read_b128 v[64:67], v128 offset:0
    ds_read_b128 v[68:71], v128 offset:8192
    ds_read_b128 v[72:75], v128 offset:16384
    v_xor_b32 v129, 320, v221
    ds_read_b128 v[76:79], v129 offset:0
    ds_read_b128 v[80:83], v129 offset:8192
    ds_read_b128 v[84:87], v129 offset:16384
    v_xor_b32 v128, 384, v221
    ds_read_b128 v[88:91], v128 offset:0
    ds_read_b128 v[92:95], v128 offset:8192
    ds_read_b128 v[96:99], v128 offset:16384
    v_xor_b32 v129, 448, v221
    ds_read_b128 v[100:103], v129 offset:0
    ds_read_b128 v[104:107], v129 offset:8192
    ds_read_b128 v[108:111], v129 offset:16384
    s_waitcnt lgkmcnt(3)
    s_waitcnt vmcnt(16)
    s_barrier
K_sig2:
    ds_read_b64_tr_b16 v[112:113], v220 offset:49152
    ds_read_b64_tr_b16 v[114:115], v220 offset:51200
    ds_read_b64_tr_b16 v[116:117], v220 offset:49160
    ds_read_b64_tr_b16 v[118:119], v220 offset:51208
    s_cmp_eq_u32 s16, 0
    s_cselect_b64 vcc, -1, 0
    s_waitcnt vmcnt(12) lgkmcnt(0)
    s_barrier
    s_cbranch_vccnz K_d8n
    v_mfma_f32_16x16x32_bf16 v[228:231], v[112:115], v[16:19], 0
    ds_read_b64_tr_b16 v[120:121], v148 offset:0
    ds_read_b64_tr_b16 v[122:123], v148 offset:2048
    s_add_u32 m0, s63, 49152
    s_mov_b32 s11, 81920
    buffer_load_dwordx4 v212, s[92:95], s11 offen offset:0 lds
    v_mfma_f32_16x16x32_bf16 v[232:235], v[116:119], v[16:19], 0
    ds_read_b64_tr_b16 v[124:125], v148 offset:8
    ds_read_b64_tr_b16 v[126:127], v148 offset:2056
    buffer_load_dwordx4 v213, s[92:95], s11 offen offset:1024 lds
    v_mfma_f32_16x16x32_bf16 v[236:239], v[112:115], v[20:23], 0
    buffer_load_dwordx4 v212, s[92:95], s11 offen offset:2048 lds
    v_mfma_f32_16x16x32_bf16 v[240:243], v[116:119], v[20:23], 0
    buffer_load_dwordx4 v213, s[92:95], s11 offen offset:3072 lds
    v_mfma_f32_16x16x32_bf16 v[244:247], v[112:115], v[24:27], 0
    v_mfma_f32_16x16x32_bf16 v[248:251], v[116:119], v[24:27], 0
    s_branch K_e8n
K_d8n:
    v_mfma_f32_16x16x32_bf16 v[228:231], v[112:115], v[16:19], 0
    ds_read_b64_tr_b16 v[120:121], v148 offset:0
    ds_read_b64_tr_b16 v[122:123], v148 offset:2048
    v_mfma_f32_16x16x32_bf16 v[232:235], v[116:119], v[16:19], 0
    ds_read_b64_tr_b16 v[124:125], v148 offset:8
    ds_read_b64_tr_b16 v[126:127], v148 offset:2056
    v_mfma_f32_16x16x32_bf16 v[236:239], v[112:115], v[20:23], 0
    v_mfma_f32_16x16x32_bf16 v[240:243], v[116:119], v[20:23], 0
    v_mfma_f32_16x16x32_bf16 v[244:247], v[112:115], v[24:27], 0
    v_mfma_f32_16x16x32_bf16 v[248:251], v[116:119], v[24:27], 0
K_e8n:
    s_waitcnt vmcnt(12) lgkmcnt(0)
    s_barrier
    s_cbranch_vccnz K_d9n
    v_mfma_f32_16x16x32_bf16 v[228:231], v[120:123], v[28:31], v[228:231]
    ds_read_b64_tr_b16 v[112:113], v220 offset:0
    ds_read_b64_tr_b16 v[114:115], v220 offset:2048
    s_add_u32 m0, s63, 65536
    s_mov_b32 s11, 98304
    buffer_load_dwordx4 v212, s[92:95], s11 offen offset:0 lds
    v_mfma_f32_16x16x32_bf16 v[232:235], v[124:127], v[28:31], v[232:235]
    ds_read_b64_tr_b16 v[116:117], v220 offset:8
    ds_read_b64_tr_b16 v[118:119], v220 offset:2056
    buffer_load_dwordx4 v213, s[92:95], s11 offen offset:1024 lds
    v_mfma_f32_16x16x32_bf16 v[236:239], v[120:123], v[32:35], v[236:239]
    buffer_load_dwordx4 v212, s[92:95], s11 offen offset:2048 lds
    v_mfma_f32_16x16x32_bf16 v[240:243], v[124:127], v[32:35], v[240:243]
    buffer_load_dwordx4 v213, s[92:95], s11 offen offset:3072 lds
    v_mfma_f32_16x16x32_bf16 v[244:247], v[120:123], v[36:39], v[244:247]
    v_mfma_f32_16x16x32_bf16 v[248:251], v[124:127], v[36:39], v[248:251]
    s_branch K_e9n
K_d9n:
    v_mfma_f32_16x16x32_bf16 v[228:231], v[120:123], v[28:31], v[228:231]
    ds_read_b64_tr_b16 v[112:113], v220 offset:0
    ds_read_b64_tr_b16 v[114:115], v220 offset:2048
    v_mfma_f32_16x16x32_bf16 v[232:235], v[124:127], v[28:31], v[232:235]
    ds_read_b64_tr_b16 v[116:117], v220 offset:8
    ds_read_b64_tr_b16 v[118:119], v220 offset:2056
    v_mfma_f32_16x16x32_bf16 v[236:239], v[120:123], v[32:35], v[236:239]
    v_mfma_f32_16x16x32_bf16 v[240:243], v[124:127], v[32:35], v[240:243]
    v_mfma_f32_16x16x32_bf16 v[244:247], v[120:123], v[36:39], v[244:247]
    v_mfma_f32_16x16x32_bf16 v[248:251], v[124:127], v[36:39], v[248:251]
K_e9n:
K_q:
    s_cmp_lg_u32 s3, 4
    s_cbranch_scc1 K_npc0
    v_and_b32 v130, 3, v9
    v_lshlrev_b32 v130, 6, v130
    buffer_load_dword v131, v130, s[88:91], 0 offen sc0 sc1
K_npc0:
    s_waitcnt vmcnt(12) lgkmcnt(0)
    s_barrier
    s_cbranch_vccnz K_d10
    v_mfma_f32_16x16x32_bf16 v[228:231], v[112:115], v[40:43], v[228:231]
    ds_read_b64_tr_b16 v[120:121], v220 offset:16384
    ds_read_b64_tr_b16 v[122:123], v220 offset:18432
    s_add_u32 m0, s63, 0
    s_mov_b32 s11, 114688
    buffer_load_dwordx4 v212, s[92:95], s11 offen offset:0 lds
    v_mfma_f32_16x16x32_bf16 v[232:235], v[116:119], v[40:43], v[232:235]
    ds_read_b64_tr_b16 v[124:125], v220 offset:16392
    ds_read_b64_tr_b16 v[126:127], v220 offset:18440
    buffer_load_dwordx4 v213, s[92:95], s11 offen offset:1024 lds
    v_mfma_f32_16x16x32_bf16 v[236:239], v[112:115], v[44:47], v[236:239]
    buffer_load_dwordx4 v212, s[92:95], s11 offen offset:2048 lds
    v_mfma_f32_16x16x32_bf16 v[240:243], v[116:119], v[44:47], v[240:243]
    buffer_load_dwordx4 v213, s[92:95], s11 offen offset:3072 lds
    v_mfma_f32_16x16x32_bf16 v[244:247], v[112:115], v[48:51], v[244:247]
    v_mfma_f32_16x16x32_bf16 v[248:251], v[116:119], v[48:51], v[248:251]
    s_branch K_e10
K_d10:
    v_mfma_f32_16x16x32_bf16 v[228:231], v[112:115], v[40:43], v[228:231]
    ds_read_b64_tr_b16 v[120:121], v220 offset:16384
    ds_read_b64_tr_b16 v[122:123], v220 offset:18432
    v_mfma_f32_16x16x32_bf16 v[232:235], v[116:119], v[40:43], v[232:235]
    ds_read_b64_tr_b16 v[124:125], v220 offset:16392
    ds_read_b64_tr_b16 v[126:127], v220 offset:18440
    v_mfma_f32_16x16x32_bf16 v[236:239], v[112:115], v[44:47], v[236:239]
    v_mfma_f32_16x16x32_bf16 v[240:243], v[116:119], v[44:47], v[240:243]
    v_mfma_f32_16x16x32_bf16 v[244:247], v[112:115], v[48:51], v[244:247]
    v_mfma_f32_16x16x32_bf16 v[248:251], v[116:119], v[48:51], v[248:251]
K_e10:
    s_waitcnt vmcnt(12) lgkmcnt(0)
    s_barrier
    s_cbranch_vccnz K_d11
    v_mfma_f32_16x16x32_bf16 v[228:231], v[120:123], v[52:55], v[228:231]
    ds_read_b64_tr_b16 v[112:113], v220 offset:32768
    ds_read_b64_tr_b16 v[114:115], v220 offset:34816
    s_add_u32 m0, s63, 16384
    s_mov_b32 s11, 131072
    buffer_load_dwordx4 v212, s[64:67], s11 offen offset:0 lds
    v_mfma_f32_16x16x32_bf16 v[232:235], v[124:127], v[52:55], v[232:235]
    ds_read_b64_tr_b16 v[116:117], v220 offset:32776
    ds_read_b64_tr_b16 v[118:119], v220 offset:34824
    buffer_load_dwordx4 v213, s[64:67], s11 offen offset:1024 lds
    v_mfma_f32_16x16x32_bf16 v[236:239], v[120:123], v[56:59], v[236:239]
    buffer_load_dwordx4 v212, s[64:67], s11 offen offset:2048 lds
    v_mfma_f32_16x16x32_bf16 v[240:243], v[124:127], v[56:59], v[240:243]
    buffer_load_dwordx4 v213, s[64:67], s11 offen offset:3072 lds
    v_mfma_f32_16x16x32_bf16 v[244:247], v[120:123], v[60:63], v[244:247]
    v_mfma_f32_16x16x32_bf16 v[248:251], v[124:127], v[60:63], v[248:251]
    s_branch K_e11
K_d11:
    v_mfma_f32_16x16x32_bf16 v[228:231], v[120:123], v[52:55], v[228:231]
    ds_read_b64_tr_b16 v[112:113], v220 offset:32768
    ds_read_b64_tr_b16 v[114:115], v220 offset:34816
    v_mfma_f32_16x16x32_bf16 v[232:235], v[124:127], v[52:55], v[232:235]
    ds_read_b64_tr_b16 v[116:117], v220 offset:32776
    ds_read_b64_tr_b16 v[118:119], v220 offset:34824
    v_mfma_f32_16x16x32_bf16 v[236:239], v[120:123], v[56:59], v[236:239]
    v_mfma_f32_16x16x32_bf16 v[240:243], v[124:127], v[56:59], v[240:243]
    v_mfma_f32_16x16x32_bf16 v[244:247], v[120:123], v[60:63], v[244:247]
    v_mfma_f32_16x16x32_bf16 v[248:251], v[124:127], v[60:63], v[248:251]
K_e11:
    s_waitcnt vmcnt(12) lgkmcnt(0)
    s_barrier
    s_cbranch_vccnz K_d12
    v_mfma_f32_16x16x32_bf16 v[228:231], v[112:115], v[64:67], v[228:231]
    ds_read_b64_tr_b16 v[120:121], v220 offset:49152
    ds_read_b64_tr_b16 v[122:123], v220 offset:51200
    s_add_u32 m0, s63, 32768
    s_mov_b32 s11, 147456
    buffer_load_dwordx4 v212, s[64:67], s11 offen offset:0 lds
    v_mfma_f32_16x16x32_bf16 v[232:235], v[116:119], v[64:67], v[232:235]
    ds_read_b64_tr_b16 v[124:125], v220 offset:49160
    ds_read_b64_tr_b16 v[126:127], v220 offset:51208
    buffer_load_dwordx4 v213, s[64:67], s11 offen offset:1024 lds
    v_mfma_f32_16x16x32_bf16 v[236:239], v[112:115], v[68:71], v[236:239]
    buffer_load_dwordx4 v212, s[64:67], s11 offen offset:2048 lds
    v_mfma_f32_16x16x32_bf16 v[240:243], v[116:119], v[68:71], v[240:243]
    buffer_load_dwordx4 v213, s[64:67], s11 offen offset:3072 lds
    v_mfma_f32_16x16x32_bf16 v[244:247], v[112:115], v[72:75], v[244:247]
    v_mfma_f32_16x16x32_bf16 v[248:251], v[116:119], v[72:75], v[248:251]
    s_branch K_e12
K_d12:
    v_mfma_f32_16x16x32_bf16 v[228:231], v[112:115], v[64:67], v[228:231]
    ds_read_b64_tr_b16 v[120:121], v220 offset:49152
    ds_read_b64_tr_b16 v[122:123], v220 offset:51200
    v_mfma_f32_16x16x32_bf16 v[232:235], v[116:119], v[64:67], v[232:235]
    ds_read_b64_tr_b16 v[124:125], v220 offset:49160
    ds_read_b64_tr_b16 v[126:127], v220 offset:51208
    v_mfma_f32_16x16x32_bf16 v[236:239], v[112:115], v[68:71], v[236:239]
    v_mfma_f32_16x16x32_bf16 v[240:243], v[116:119], v[68:71], v[240:243]
    v_mfma_f32_16x16x32_bf16 v[244:247], v[112:115], v[72:75], v[244:247]
    v_mfma_f32_16x16x32_bf16 v[248:251], v[116:119], v[72:75], v[248:251]
K_e12:
    s_waitcnt vmcnt(12) lgkmcnt(0)
    s_barrier
    s_cbranch_vccnz K_d13
    v_mfma_f32_16x16x32_bf16 v[228:231], v[120:123], v[76:79], v[228:231]
    ds_read_b64_tr_b16 v[112:113], v148 offset:0
    ds_read_b64_tr_b16 v[114:115], v148 offset:2048
    s_add_u32 m0, s63, 49152
    s_mov_b32 s11, 163840
    buffer_load_dwordx4 v212, s[64:67], s11 offen offset:0 lds
    v_mfma_f32_16x16x32_bf16 v[232:235], v[124:127], v[76:79], v[232:235]
    ds_read_b64_tr_b16 v[116:117], v148 offset:8
    ds_read_b64_tr_b16 v[118:119], v148 offset:2056
    buffer_load_dwordx4 v213, s[64:67], s11 offen offset:1024 lds
    v_mfma_f32_16x16x32_bf16 v[236:239], v[120:123], v[80:83], v[236:239]
    buffer_load_dwordx4 v212, s[64:67], s11 offen offset:2048 lds
    v_mfma_f32_16x16x32_bf16 v[240:243], v[124:127], v[80:83], v[240:243]
    buffer_load_dwordx4 v213, s[64:67], s11 offen offset:3072 lds
    v_mfma_f32_16x16x32_bf16 v[244:247], v[120:123], v[84:87], v[244:247]
    v_mfma_f32_16x16x32_bf16 v[248:251], v[124:127], v[84:87], v[248:251]
    s_branch K_e13
K_d13:
    v_mfma_f32_16x16x32_bf16 v[228:231], v[120:123], v[76:79], v[228:231]
    ds_read_b64_tr_b16 v[112:113], v148 offset:0
    ds_read_b64_tr_b16 v[114:115], v148 offset:2048
    v_mfma_f32_16x16x32_bf16 v[232:235], v[124:127], v[76:79], v[232:235]
    ds_read_b64_tr_b16 v[116:117], v148 offset:8
    ds_read_b64_tr_b16 v[118:119], v148 offset:2056
    v_mfma_f32_16x16x32_bf16 v[236:239], v[120:123], v[80:83], v[236:239]
    v_mfma_f32_16x16x32_bf16 v[240:243], v[124:127], v[80:83], v[240:243]
    v_mfma_f32_16x16x32_bf16 v[244:247], v[120:123], v[84:87], v[244:247]
    v_mfma_f32_16x16x32_bf16 v[248:251], v[124:127], v[84:87], v[248:251]
K_e13:
    s_cmp_lg_u32 s3, 4
    s_cbranch_scc1 K_npcp
    s_mov_b32 s11, 400000
    s_waitcnt vmcnt(16)
K_pcp:
    v_cmp_gt_u32 s[96:97], 8, v131
    s_cmp_eq_u64 s[96:97], 0
    s_cbranch_scc1 K_npcp
    buffer_load_dword v131, v130, s[88:91], 0 offen sc0 sc1
    s_waitcnt vmcnt(0)
    s_sub_u32 s11, s11, 1
    s_cbranch_scc0 K_pcp
K_npcp:
    s_cbranch_vccz K_fw
    s_waitcnt vmcnt(0)
K_fw:
    s_waitcnt vmcnt(12) lgkmcnt(0)
    s_barrier
    s_cmp_lg_u32 s3, 0
    s_cbranch_scc1 K_nflp
    s_mov_b64 exec, 1
    buffer_store_dword v226, v225, s[28:31], s10 offen sc0 sc1
    s_mov_b64 exec, -1
K_nflp:
    s_cbranch_vccnz K_d14
    v_mfma_f32_16x16x32_bf16 v[228:231], v[112:115], v[88:91], v[228:231]
    ds_read_b64_tr_b16 v[120:121], v220 offset:0
    ds_read_b64_tr_b16 v[122:123], v220 offset:2048
    s_add_u32 m0, s63, 65536
    s_mov_b32 s11, 180224
    buffer_load_dwordx4 v212, s[64:67], s11 offen offset:0 lds
    v_mfma_f32_16x16x32_bf16 v[232:235], v[116:119], v[88:91], v[232:235]
    ds_read_b64_tr_b16 v[124:125], v220 offset:8
    ds_read_b64_tr_b16 v[126:127], v220 offset:2056
    buffer_load_dwordx4 v213, s[64:67], s11 offen offset:1024 lds
    v_mfma_f32_16x16x32_bf16 v[236:239], v[112:115], v[92:95], v[236:239]
    buffer_load_dwordx4 v212, s[64:67], s11 offen offset:2048 lds
    v_mfma_f32_16x16x32_bf16 v[240:243], v[116:119], v[92:95], v[240:243]
    buffer_load_dwordx4 v213, s[64:67], s11 offen offset:3072 lds
    v_mfma_f32_16x16x32_bf16 v[244:247], v[112:115], v[96:99], v[244:247]
    v_mfma_f32_16x16x32_bf16 v[248:251], v[116:119], v[96:99], v[248:251]
    s_branch K_e14
K_d14:
    v_mfma_f32_16x16x32_bf16 v[228:231], v[112:115], v[88:91], v[228:231]
    ds_read_b64_tr_b16 v[120:121], v220 offset:0
    ds_read_b64_tr_b16 v[122:123], v220 offset:2048
    v_mfma_f32_16x16x32_bf16 v[232:235], v[116:119], v[88:91], v[232:235]
    ds_read_b64_tr_b16 v[124:125], v220 offset:8
    ds_read_b64_tr_b16 v[126:127], v220 offset:2056
    v_mfma_f32_16x16x32_bf16 v[236:239], v[112:115], v[92:95], v[236:239]
    v_mfma_f32_16x16x32_bf16 v[240:243], v[116:119], v[92:95], v[240:243]
    v_mfma_f32_16x16x32_bf16 v[244:247], v[112:115], v[96:99], v[244:247]
    v_mfma_f32_16x16x32_bf16 v[248:251], v[116:119], v[96:99], v[248:251]
K_e14:
    s_waitcnt vmcnt(12) lgkmcnt(0)
    s_barrier
    s_cbranch_vccnz K_d15
    v_mfma_f32_16x16x32_bf16 v[228:231], v[120:123], v[100:103], v[228:231]
    ds_read_b64_tr_b16 v[112:113], v220 offset:16384
    ds_read_b64_tr_b16 v[114:115], v220 offset:18432
    s_add_u32 m0, s63, 0
    s_mov_b32 s11, 196608
    buffer_load_dwordx4 v212, s[64:67], s11 offen offset:0 lds
    v_mfma_f32_16x16x32_bf16 v[232:235], v[124:127], v[100:103], v[232:235]
    ds_read_b64_tr_b16 v[116:117], v220 offset:16392
    ds_read_b64_tr_b16 v[118:119], v220 offset:18440
    buffer_load_dwordx4 v213, s[64:67], s11 offen offset:1024 lds
    v_mfma_f32_16x16x32_bf16 v[236:239], v[120:123], v[104:107], v[236:239]
    buffer_load_dwordx4 v212, s[64:67], s11 offen offset:2048 lds
    v_mfma_f32_16x16x32_bf16 v[240:243], v[124:127], v[104:107], v[240:243]
    buffer_load_dwordx4 v213, s[64:67], s11 offen offset:3072 lds
    v_mfma_f32_16x16x32_bf16 v[244:247], v[120:123], v[108:111], v[244:247]
    v_mfma_f32_16x16x32_bf16 v[248:251], v[124:127], v[108:111], v[248:251]
    s_branch K_e15
K_d15:
    v_mfma_f32_16x16x32_bf16 v[228:231], v[120:123], v[100:103], v[228:231]
    ds_read_b64_tr_b16 v[112:113], v220 offset:16384
    ds_read_b64_tr_b16 v[114:115], v220 offset:18432
    v_mfma_f32_16x16x32_bf16 v[232:235], v[124:127], v[100:103], v[232:235]
    ds_read_b64_tr_b16 v[116:117], v220 offset:16392
    ds_read_b64_tr_b16 v[118:119], v220 offset:18440
    v_mfma_f32_16x16x32_bf16 v[236:239], v[120:123], v[104:107], v[236:239]
    v_mfma_f32_16x16x32_bf16 v[240:243], v[124:127], v[104:107], v[240:243]
    v_mfma_f32_16x16x32_bf16 v[244:247], v[120:123], v[108:111], v[244:247]
    v_mfma_f32_16x16x32_bf16 v[248:251], v[124:127], v[108:111], v[248:251]
K_e15:
    s_waitcnt vmcnt(12) lgkmcnt(0)
    s_barrier
    s_cmp_lg_u32 s3, 4
    s_cbranch_scc1 K_npa0
    s_mov_b32 s62, 7891840
    v_lshlrev_b32 v130, 7, v253
    buffer_load_dword v131, v130, s[28:31], s62 offen sc0 sc1
K_npa0:
    s_cbranch_vccnz K_d16
    v_mfma_f32_16x16x32_bf16 v[164:167], v[112:115], v[16:19], 0
    ds_read_b64_tr_b16 v[120:121], v220 offset:32768
    ds_read_b64_tr_b16 v[122:123], v220 offset:34816
    s_add_u32 m0, s63, 16384
    s_mov_b32 s11, 212992
    buffer_load_dwordx4 v212, s[64:67], s11 offen offset:0 lds
    v_mfma_f32_16x16x32_bf16 v[168:171], v[116:119], v[16:19], 0
    ds_read_b64_tr_b16 v[124:125], v220 offset:32776
    ds_read_b64_tr_b16 v[126:127], v220 offset:34824
    buffer_load_dwordx4 v213, s[64:67], s11 offen offset:1024 lds
    v_mfma_f32_16x16x32_bf16 v[172:175], v[112:115], v[20:23], 0
    buffer_load_dwordx4 v212, s[64:67], s11 offen offset:2048 lds
    v_mfma_f32_16x16x32_bf16 v[176:179], v[116:119], v[20:23], 0
    buffer_load_dwordx4 v213, s[64:67], s11 offen offset:3072 lds
    v_mfma_f32_16x16x32_bf16 v[180:183], v[112:115], v[24:27], 0
    v_mfma_f32_16x16x32_bf16 v[184:187], v[116:119], v[24:27], 0
    s_branch K_e16
K_d16:
    v_mfma_f32_16x16x32_bf16 v[164:167], v[112:115], v[16:19], 0
    ds_read_b64_tr_b16 v[120:121], v220 offset:32768
    ds_read_b64_tr_b16 v[122:123], v220 offset:34816
    v_mfma_f32_16x16x32_bf16 v[168:171], v[116:119], v[16:19], 0
    ds_read_b64_tr_b16 v[124:125], v220 offset:32776
    ds_read_b64_tr_b16 v[126:127], v220 offset:34824
    v_mfma_f32_16x16x32_bf16 v[172:175], v[112:115], v[20:23], 0
    v_mfma_f32_16x16x32_bf16 v[176:179], v[116:119], v[20:23], 0
    v_mfma_f32_16x16x32_bf16 v[180:183], v[112:115], v[24:27], 0
    v_mfma_f32_16x16x32_bf16 v[184:187], v[116:119], v[24:27], 0
K_e16:
    s_waitcnt vmcnt(12) lgkmcnt(0)
    s_barrier
    s_cbranch_vccnz K_d17
    v_mfma_f32_16x16x32_bf16 v[164:167], v[120:123], v[28:31], v[164:167]
    ds_read_b64_tr_b16 v[112:113], v220 offset:49152
    ds_read_b64_tr_b16 v[114:115], v220 offset:51200
    s_add_u32 m0, s63, 32768
    s_mov_b32 s11, 229376
    buffer_load_dwordx4 v212, s[64:67], s11 offen offset:0 lds
    v_mfma_f32_16x16x32_bf16 v[168:171], v[124:127], v[28:31], v[168:171]
    ds_read_b64_tr_b16 v[116:117], v220 offset:49160
    ds_read_b64_tr_b16 v[118:119], v220 offset:51208
    buffer_load_dwordx4 v213, s[64:67], s11 offen offset:1024 lds
    v_mfma_f32_16x16x32_bf16 v[172:175], v[120:123], v[32:35], v[172:175]
    buffer_load_dwordx4 v212, s[64:67], s11 offen offset:2048 lds
    v_mfma_f32_16x16x32_bf16 v[176:179], v[124:127], v[32:35], v[176:179]
    buffer_load_dwordx4 v213, s[64:67], s11 offen offset:3072 lds
    v_mfma_f32_16x16x32_bf16 v[180:183], v[120:123], v[36:39], v[180:183]
    v_mfma_f32_16x16x32_bf16 v[184:187], v[124:127], v[36:39], v[184:187]
    s_branch K_e17
K_d17:
    v_mfma_f32_16x16x32_bf16 v[164:167], v[120:123], v[28:31], v[164:167]
    ds_read_b64_tr_b16 v[112:113], v220 offset:49152
    ds_read_b64_tr_b16 v[114:115], v220 offset:51200
    v_mfma_f32_16x16x32_bf16 v[168:171], v[124:127], v[28:31], v[168:171]
    ds_read_b64_tr_b16 v[116:117], v220 offset:49160
    ds_read_b64_tr_b16 v[118:119], v220 offset:51208
    v_mfma_f32_16x16x32_bf16 v[172:175], v[120:123], v[32:35], v[172:175]
    v_mfma_f32_16x16x32_bf16 v[176:179], v[124:127], v[32:35], v[176:179]
    v_mfma_f32_16x16x32_bf16 v[180:183], v[120:123], v[36:39], v[180:183]
    v_mfma_f32_16x16x32_bf16 v[184:187], v[124:127], v[36:39], v[184:187]
K_e17:
    s_waitcnt vmcnt(12) lgkmcnt(0)
    s_barrier
    s_cbranch_vccnz K_d18
    v_mfma_f32_16x16x32_bf16 v[164:167], v[112:115], v[40:43], v[164:167]
    ds_read_b64_tr_b16 v[120:121], v148 offset:0
    ds_read_b64_tr_b16 v[122:123], v148 offset:2048
    s_add_u32 m0, s63, 49152
    s_mov_b32 s11, 245760
    buffer_load_dwordx4 v212, s[64:67], s11 offen offset:0 lds
    v_mfma_f32_16x16x32_bf16 v[168:171], v[116:119], v[40:43], v[168:171]
    ds_read_b64_tr_b16 v[124:125], v148 offset:8
    ds_read_b64_tr_b16 v[126:127], v148 offset:2056
    buffer_load_dwordx4 v213, s[64:67], s11 offen offset:1024 lds
    v_mfma_f32_16x16x32_bf16 v[172:175], v[112:115], v[44:47], v[172:175]
    buffer_load_dwordx4 v212, s[64:67], s11 offen offset:2048 lds
    v_mfma_f32_16x16x32_bf16 v[176:179], v[116:119], v[44:47], v[176:179]
    buffer_load_dwordx4 v213, s[64:67], s11 offen offset:3072 lds
    v_mfma_f32_16x16x32_bf16 v[180:183], v[112:115], v[48:51], v[180:183]
    v_mfma_f32_16x16x32_bf16 v[184:187], v[116:119], v[48:51], v[184:187]
    s_branch K_e18
K_d18:
    v_mfma_f32_16x16x32_bf16 v[164:167], v[112:115], v[40:43], v[164:167]
    ds_read_b64_tr_b16 v[120:121], v148 offset:0
    ds_read_b64_tr_b16 v[122:123], v148 offset:2048
    v_mfma_f32_16x16x32_bf16 v[168:171], v[116:119], v[40:43], v[168:171]
    ds_read_b64_tr_b16 v[124:125], v148 offset:8
    ds_read_b64_tr_b16 v[126:127], v148 offset:2056
    v_mfma_f32_16x16x32_bf16 v[172:175], v[112:115], v[44:47], v[172:175]
    v_mfma_f32_16x16x32_bf16 v[176:179], v[116:119], v[44:47], v[176:179]
    v_mfma_f32_16x16x32_bf16 v[180:183], v[112:115], v[48:51], v[180:183]
    v_mfma_f32_16x16x32_bf16 v[184:187], v[116:119], v[48:51], v[184:187]
K_e18:
    s_waitcnt vmcnt(12) lgkmcnt(0)
    s_barrier
    v_mfma_f32_16x16x32_bf16 v[164:167], v[120:123], v[52:55], v[164:167]
    ds_read_b64_tr_b16 v[112:113], v220 offset:0
    ds_read_b64_tr_b16 v[114:115], v220 offset:2048
    v_mul_f32 v228, s68, v228
    v_mul_f32 v229, s68, v229
    v_mfma_f32_16x16x32_bf16 v[168:171], v[124:127], v[52:55], v[168:171]
    ds_read_b64_tr_b16 v[116:117], v220 offset:8
    ds_read_b64_tr_b16 v[118:119], v220 offset:2056
    v_mul_f32 v230, s68, v230
    v_mul_f32 v231, s68, v231
    v_mfma_f32_16x16x32_bf16 v[172:175], v[120:123], v[56:59], v[172:175]
    v_mul_f32 v232, s68, v232
    v_mul_f32 v233, s68, v233
    v_mfma_f32_16x16x32_bf16 v[176:179], v[124:127], v[56:59], v[176:179]
    v_mul_f32 v234, s68, v234
    v_mul_f32 v235, s68, v235
    v_mfma_f32_16x16x32_bf16 v[180:183], v[120:123], v[60:63], v[180:183]
    v_mul_f32 v236, s68, v236
    v_mul_f32 v237, s68, v237
    v_mfma_f32_16x16x32_bf16 v[184:187], v[124:127], v[60:63], v[184:187]
    v_mul_f32 v238, s68, v238
    v_mul_f32 v239, s68, v239
    s_cmp_lg_u32 s3, 4
    s_cbranch_scc1 K_npa
    s_mov_b32 s11, 400000
    s_waitcnt vmcnt(12)
K_pa:
    v_cmp_ne_u32 s[96:97], 1, v131
    s_cmp_eq_u64 s[96:97], 0
    s_cbranch_scc1 K_npa
    buffer_load_dword v131, v130, s[28:31], s62 offen sc0 sc1
    s_waitcnt vmcnt(0)
    s_sub_u32 s11, s11, 1
    s_cbranch_scc0 K_pa
K_npa:
    s_waitcnt vmcnt(8) lgkmcnt(0)
    s_barrier
    buffer_load_dwordx4 v[128:131], v7, s[28:31], s14 offen sc1
    v_mfma_f32_16x16x32_bf16 v[164:167], v[112:115], v[64:67], v[164:167]
    ds_read_b64_tr_b16 v[120:121], v220 offset:16384
    ds_read_b64_tr_b16 v[122:123], v220 offset:18432
    v_mul_f32 v240, s68, v240
    v_mul_f32 v241, s68, v241
    v_mfma_f32_16x16x32_bf16 v[168:171], v[116:119], v[64:67], v[168:171]
    ds_read_b64_tr_b16 v[124:125], v220 offset:16392
    ds_read_b64_tr_b16 v[126:127], v220 offset:18440
    v_mul_f32 v242, s68, v242
    v_mul_f32 v243, s68, v243
    v_mfma_f32_16x16x32_bf16 v[172:175], v[112:115], v[68:71], v[172:175]
    v_mul_f32 v244, s68, v244
    v_mul_f32 v245, s68, v245
    v_mfma_f32_16x16x32_bf16 v[176:179], v[116:119], v[68:71], v[176:179]
    v_mul_f32 v246, s68, v246
    v_mul_f32 v247, s68, v247
    v_mfma_f32_16x16x32_bf16 v[180:183], v[112:115], v[72:75], v[180:183]
    v_mul_f32 v248, s68, v248
    v_mul_f32 v249, s68, v249
    v_mfma_f32_16x16x32_bf16 v[184:187], v[116:119], v[72:75], v[184:187]
    v_mul_f32 v250, s68, v250
    v_mul_f32 v251, s68, v251
    s_waitcnt vmcnt(5) lgkmcnt(0)
    s_barrier
    v_mfma_f32_16x16x32_bf16 v[164:167], v[120:123], v[76:79], v[164:167]
    ds_read_b64_tr_b16 v[112:113], v220 offset:32768
    ds_read_b64_tr_b16 v[114:115], v220 offset:34816
    v_mfma_f32_16x16x32_bf16 v[168:171], v[124:127], v[76:79], v[168:171]
    ds_read_b64_tr_b16 v[116:117], v220 offset:32776
    ds_read_b64_tr_b16 v[118:119], v220 offset:34824
    v_mfma_f32_16x16x32_bf16 v[172:175], v[120:123], v[80:83], v[172:175]
    v_mfma_f32_16x16x32_bf16 v[176:179], v[124:127], v[80:83], v[176:179]
    v_mfma_f32_16x16x32_bf16 v[180:183], v[120:123], v[84:87], v[180:183]
    v_mfma_f32_16x16x32_bf16 v[184:187], v[124:127], v[84:87], v[184:187]
    s_waitcnt vmcnt(1) lgkmcnt(0)
    s_barrier
    v_mfma_f32_16x16x32_bf16 v[164:167], v[112:115], v[88:91], v[164:167]
    ds_read_b64_tr_b16 v[120:121], v220 offset:49152
    ds_read_b64_tr_b16 v[122:123], v220 offset:51200
    v_mfma_f32_16x16x32_bf16 v[168:171], v[116:119], v[88:91], v[168:171]
    ds_read_b64_tr_b16 v[124:125], v220 offset:49160
    ds_read_b64_tr_b16 v[126:127], v220 offset:51208
    v_mfma_f32_16x16x32_bf16 v[172:175], v[112:115], v[92:95], v[172:175]
    v_mfma_f32_16x16x32_bf16 v[176:179], v[116:119], v[92:95], v[176:179]
    v_mfma_f32_16x16x32_bf16 v[180:183], v[112:115], v[96:99], v[180:183]
    v_mfma_f32_16x16x32_bf16 v[184:187], v[116:119], v[96:99], v[184:187]
    s_waitcnt lgkmcnt(0)
    v_mfma_f32_16x16x32_bf16 v[164:167], v[120:123], v[100:103], v[164:167]
    v_mfma_f32_16x16x32_bf16 v[168:171], v[124:127], v[100:103], v[168:171]
    v_mfma_f32_16x16x32_bf16 v[172:175], v[120:123], v[104:107], v[172:175]
    v_mfma_f32_16x16x32_bf16 v[176:179], v[124:127], v[104:107], v[176:179]
    v_mfma_f32_16x16x32_bf16 v[180:183], v[120:123], v[108:111], v[180:183]
    v_mfma_f32_16x16x32_bf16 v[184:187], v[124:127], v[108:111], v[184:187]
    v_mov_b32 v253, v10
    s_mov_b32 s7, 7864320
    s_lshl_b32 s10, s3, 14
    buffer_load_dword v153, v152, s[28:31], s7 offen sc0 sc1
    s_nop 0
    v_pk_mul_f32 v[164:165], v[164:165], s[68:69]
    v_pk_mul_f32 v[166:167], v[166:167], s[68:69]
    v_pk_mul_f32 v[168:169], v[168:169], s[68:69]
    v_pk_mul_f32 v[170:171], v[170:171], s[68:69]
    v_cvt_pk_bf16_f32 v188, v164, v165
    v_cvt_pk_bf16_f32 v189, v166, v167
    v_cvt_pk_bf16_f32 v190, v168, v169
    v_cvt_pk_bf16_f32 v191, v170, v171
    ds_write_b128 v150, v[188:191] offset:0
    v_pk_mul_f32 v[172:173], v[172:173], s[68:69]
    v_pk_mul_f32 v[174:175], v[174:175], s[68:69]
    v_pk_mul_f32 v[176:177], v[176:177], s[68:69]
    v_pk_mul_f32 v[178:179], v[178:179], s[68:69]
    v_cvt_pk_bf16_f32 v192, v172, v173
    v_cvt_pk_bf16_f32 v193, v174, v175
    v_cvt_pk_bf16_f32 v194, v176, v177
    v_cvt_pk_bf16_f32 v195, v178, v179
    ds_write_b128 v150, v[192:195] offset:1024
    v_pk_mul_f32 v[180:181], v[180:181], s[68:69]
    v_pk_mul_f32 v[182:183], v[182:183], s[68:69]
    v_pk_mul_f32 v[184:185], v[184:185], s[68:69]
    v_pk_mul_f32 v[186:187], v[186:187], s[68:69]
    v_cvt_pk_bf16_f32 v196, v180, v181
    v_cvt_pk_bf16_f32 v197, v182, v183
    v_cvt_pk_bf16_f32 v198, v184, v185
    v_cvt_pk_bf16_f32 v199, v186, v187
    ds_write_b128 v150, v[196:199] offset:2048
    s_waitcnt vmcnt(1)
K_havrec:
    v_cmp_gt_u32 s[62:63], -3, v128
    v_cmp_gt_u32 s[64:65], -3, v129
    v_cmp_gt_u32 s[66:67], -3, v130
    v_cmp_gt_u32 s[68:69], -3, v131
    v_cmp_eq_u32 vcc, -2, v128
    s_bcnt1_i32_b64 s86, s[62:63]
    s_bcnt1_i32_b64 s87, s[64:65]
    s_bcnt1_i32_b64 s88, s[66:67]
    s_bcnt1_i32_b64 s89, s[68:69]
    s_lshl_b32 s61, s16, 2
    s_add_u32 s61, s61, 131584
    s_add_u32 s87, s87, s86
    s_add_u32 s88, s88, s87
    s_add_u32 s89, s89, s88
    v_mov_b32 v125, s61
    v_mov_b32 v126, s89
    s_mov_b64 exec, 1
    ds_add_rtn_u32 v127, v125, v126
    s_mov_b64 exec, -1
    s_cbranch_vccz K_nomark
    v_bfe_u32 v122, v0, 3, 5
    v_lshlrev_b32 v122, v122, 1
    s_mov_b64 exec, vcc
    ds_or_b32 v125, v122 offset:8
    s_mov_b64 exec, -1
K_nomark:
    v_mbcnt_lo_u32_b32 v112, s62, 0
    v_mbcnt_hi_u32_b32 v112, s63, v112
    v_mbcnt_lo_u32_b32 v113, s64, 0
    v_mbcnt_hi_u32_b32 v113, s65, v113
    v_mbcnt_lo_u32_b32 v114, s66, 0
    v_mbcnt_hi_u32_b32 v114, s67, v114
    v_mbcnt_lo_u32_b32 v115, s68, 0
    v_mbcnt_hi_u32_b32 v115, s69, v115
    v_mov_b32 v124, 0x3f80
    s_movk_i32 s93, 416
    s_movk_i32 s92, 6656
    s_add_u32 s91, s15, 19968
    v_and_b32 v116, 0x3fff, v128
    v_lshlrev_b32 v116, 9, v116
    v_lshrrev_b32 v117, 19, v128
    v_add_u32 v117, v255, v117
    v_bfe_u32 v120, v128, 14, 3
    v_lshl_add_u32 v120, v120, 1, s15
    v_bfe_u32 v122, v128, 17, 2
    v_mad_u32_u24 v120, v122, s92, v120
    v_and_b32 v118, 0x3fff, v129
    v_lshlrev_b32 v118, 9, v118
    v_lshrrev_b32 v119, 19, v129
    v_add_u32 v119, v255, v119
    v_bfe_u32 v121, v129, 14, 3
    v_lshl_add_u32 v121, v121, 1, s15
    v_bfe_u32 v122, v129, 17, 2
    v_mad_u32_u24 v121, v122, s92, v121
    s_waitcnt lgkmcnt(0)
    v_readfirstlane_b32 s94, v127
    s_cmp_eq_u32 s54, 0
    s_cselect_b32 s12, s94, s12
    s_sub_u32 s94, s12, s54
    s_add_u32 s95, s94, s86
    s_add_u32 s96, s94, s87
    s_add_u32 s97, s94, s88
    v_add_u32 v112, s94, v112
    v_cmp_gt_u32 vcc, s93, v112
    s_and_b64 exec, vcc, s[62:63]
    s_cbranch_execz K_x0
    v_lshl_add_u32 v122, v112, 2, s91
    v_lshl_add_u32 v123, v112, 4, v120
    ds_write_b32 v122, v116
    ds_write_b32 v122, v117 offset:1664
    ds_write_b16 v123, v124
K_x0:
    s_mov_b64 exec, -1
    v_add_u32 v113, s95, v113
    v_cmp_gt_u32 vcc, s93, v113
    s_and_b64 exec, vcc, s[64:65]
    s_cbranch_execz K_x1
    v_lshl_add_u32 v122, v113, 2, s91
    v_lshl_add_u32 v123, v113, 4, v121
    ds_write_b32 v122, v118
    ds_write_b32 v122, v119 offset:1664
    ds_write_b16 v123, v124
K_x1:
    s_mov_b64 exec, -1
    v_add_u32 v114, s96, v114
    v_cmp_gt_u32 vcc, s93, v114
    s_and_b64 exec, vcc, s[66:67]
    s_cbranch_execz K_x2
    v_and_b32 v116, 0x3fff, v130
    v_lshlrev_b32 v116, 9, v116
    v_lshrrev_b32 v117, 19, v130
    v_add_u32 v117, v255, v117
    v_bfe_u32 v120, v130, 14, 3
    v_lshl_add_u32 v120, v120, 1, s15
    v_bfe_u32 v122, v130, 17, 2
    v_mad_u32_u24 v120, v122, s92, v120
    v_lshl_add_u32 v122, v114, 2, s91
    v_lshl_add_u32 v123, v114, 4, v120
    ds_write_b32 v122, v116
    ds_write_b32 v122, v117 offset:1664
    ds_write_b16 v123, v124
K_x2:
    s_mov_b64 exec, -1
    v_add_u32 v115, s97, v115
    v_cmp_gt_u32 vcc, s93, v115
    s_and_b64 exec, vcc, s[68:69]
    s_cbranch_execz K_x3
    v_and_b32 v118, 0x3fff, v131
    v_lshlrev_b32 v118, 9, v118
    v_lshrrev_b32 v119, 19, v131
    v_add_u32 v119, v255, v119
    v_bfe_u32 v121, v131, 14, 3
    v_lshl_add_u32 v121, v121, 1, s15
    v_bfe_u32 v122, v131, 17, 2
    v_mad_u32_u24 v121, v122, s92, v121
    v_lshl_add_u32 v122, v115, 2, s91
    v_lshl_add_u32 v123, v115, 4, v121
    ds_write_b32 v122, v118
    ds_write_b32 v122, v119 offset:1664
    ds_write_b16 v123, v124
K_x3:
    s_mov_b64 exec, -1
    v_mov_b32 v125, 131584
    v_mov_b32 v121, v15
    s_cmp_eq_u32 s13, 0
    s_cbranch_scc1 K_pb1
    s_mov_b32 s11, 400000
K_pb:
    s_waitcnt vmcnt(0)
    v_cmp_ne_u32 vcc, 1, v153
    s_cbranch_vccz K_pb1
    buffer_load_dword v153, v152, s[28:31], s7 offen sc0 sc1
    s_sub_u32 s11, s11, 1
    s_cbranch_scc0 K_pb
K_pb1:
    s_waitcnt lgkmcnt(0)
    s_barrier
    s_setprio 2
    ds_read_b128 v[112:115], v125
    ds_read_b128 v[10:13], v3 offset:0
    ds_read_b32 v14, v6 offset:0
    ds_read_b128 v[116:119], v3 offset:128
    ds_read_b32 v120, v6 offset:128
    v_mov_b32 v124, v151
    s_lshl_b32 s11, s17, 11
    s_add_u32 s11, s11, 7602176
    buffer_load_dwordx4 v[148:151], v252, s[28:31], s11 offen offset:0 sc1
    buffer_load_dwordx4 v[152:155], v252, s[28:31], s11 offen offset:1024 sc1
    s_mov_b32 s26, 5124096
    s_mov_b32 s34, 160000
    s_waitcnt lgkmcnt(2)
    v_add_u32 v10, v253, v10
    v_add_u32 v11, v253, v11
    v_add_u32 v12, v253, v12
    v_add_u32 v13, v253, v13
    s_add_u32 m0, s18, 0
    s_nop 0
    buffer_load_dwordx4 v10, s[24:27], s20 offen offset:0 sc1 lds
    buffer_load_dwordx4 v11, s[24:27], s21 offen offset:1088 sc1 lds
    buffer_load_dwordx4 v12, s[24:27], s22 offen offset:2176 sc1 lds
    buffer_load_dwordx4 v13, s[24:27], s23 offen offset:3264 sc1 lds
    s_add_u32 m0, s18, 4288
    s_nop 0
    buffer_load_dwordx4 v[14:15], s[32:35], 0 idxen offen lds
    v_readfirstlane_b32 s94, v112
    v_readfirstlane_b32 s95, v113
    v_readfirstlane_b32 s96, v114
    v_readfirstlane_b32 s97, v115
    s_waitcnt lgkmcnt(0)
    s_barrier
    v_add_u32 v116, v253, v116
    v_add_u32 v117, v253, v117
    v_add_u32 v118, v253, v118
    v_add_u32 v119, v253, v119
    s_add_u32 m0, s18, 5312
    s_nop 0
    buffer_load_dwordx4 v116, s[24:27], s20 offen offset:0 sc1 lds
    buffer_load_dwordx4 v117, s[24:27], s21 offen offset:1088 sc1 lds
    buffer_load_dwordx4 v118, s[24:27], s22 offen offset:2176 sc1 lds
    buffer_load_dwordx4 v119, s[24:27], s23 offen offset:3264 sc1 lds
    s_add_u32 m0, s18, 9600
    s_nop 0
    buffer_load_dwordx4 v[120:121], s[32:35], 0 idxen offen lds
    s_max_u32 s55, s94, s95
    s_cmp_eq_u32 s16, 0
    s_cselect_b32 s94, s94, s95
    s_sub_i32 s60, s94, s54
    s_max_i32 s60, s60, 0
    s_min_i32 s60, s60, 416
    s_add_u32 s52, s60, 31
    s_lshr_b32 s52, s52, 5
    s_cmp_eq_u32 s13, 0
    s_cbranch_scc1 K_nou
    s_mov_b32 s56, s96
    s_mov_b32 s57, s97
    ds_read_b64_tr_b16 v[132:133], v124 offset:0
    ds_read_b64_tr_b16 v[134:135], v124 offset:256
    ds_read_b64_tr_b16 v[136:137], v124 offset:512
    ds_read_b64_tr_b16 v[140:141], v124 offset:3072
    ds_read_b64_tr_b16 v[142:143], v124 offset:3328
    ds_read_b64_tr_b16 v[144:145], v124 offset:3584
    s_add_u32 s10, s10, 7471104
    s_mov_b32 s9, 0
    v_mov_b32 v16, 0
    v_mov_b32 v17, 0
    v_mov_b32 v18, 0
    v_mov_b32 v19, 0
    v_mov_b32 v20, 0
    v_mov_b32 v21, 0
    v_mov_b32 v22, 0
    v_mov_b32 v23, 0
    v_mov_b32 v24, 0
    v_mov_b32 v25, 0
    v_mov_b32 v26, 0
    v_mov_b32 v27, 0
    v_mov_b32 v28, 0
    v_mov_b32 v29, 0
    v_mov_b32 v30, 0
    v_mov_b32 v31, 0
    v_mov_b32 v32, 0
    v_mov_b32 v33, 0
    v_mov_b32 v34, 0
    v_mov_b32 v35, 0
    v_mov_b32 v36, 0
    v_mov_b32 v37, 0
    v_mov_b32 v38, 0
    v_mov_b32 v39, 0
    v_mov_b32 v40, 0
    v_mov_b32 v41, 0
    v_mov_b32 v42, 0
    v_mov_b32 v43, 0
    v_mov_b32 v44, 0
    v_mov_b32 v45, 0
    v_mov_b32 v46, 0
    v_mov_b32 v47, 0
    s_waitcnt lgkmcnt(0)
    s_mov_b32 exec_hi, 0
    v_mov_b32 v136, 0
    v_mov_b32 v137, 0
    v_mov_b32 v144, 0
    v_mov_b32 v145, 0
    s_mov_b64 exec, -1
K_nou:
    ds_read_b128 v[116:119], v1 offset:0
    ds_read_b128 v[120:123], v1 offset:6656
    v_mov_b32 v96, 0
    v_mov_b32 v97, 0
    v_mov_b32 v98, 0
    v_mov_b32 v99, 0
    v_mov_b32 v100, 0
    v_mov_b32 v101, 0
    v_mov_b32 v102, 0
    v_mov_b32 v103, 0
    v_mov_b32 v124, 0
    v_mov_b32 v125, 0
    v_mov_b32 v126, 0
    v_mov_b32 v127, 0
    v_mov_b32 v128, 0
    v_mov_b32 v129, 0
    v_mov_b32 v130, 0
    v_mov_b32 v131, 0
    s_mov_b32 s53, 0
    s_waitcnt vmcnt(5)
    s_cmp_eq_u32 s52, 0
    s_cbranch_scc1 K_rend
    ds_read_b128 v[112:115], v8 offset:4288
    ds_read_b128 v[104:107], v4 offset:0
    ds_read_b128 v[108:111], v5 offset:0
    s_setprio 1
    s_waitcnt lgkmcnt(0)
    v_mfma_f32_32x32x16_bf16 v[48:63], v[116:119], v[132:135], 0
    v_mfma_f32_32x32x16_bf16 v[48:63], v[120:123], v[136:139], v[48:63]
    v_mfma_f32_32x32x16_bf16 v[48:63], v[112:115], v[148:151], v[48:63]
    v_mfma_f32_32x32x16_bf16 v[48:63], v[104:107], v[156:159], v[48:63]
    v_mfma_f32_32x32x16_bf16 v[48:63], v[108:111], v[160:163], v[48:63]
    s_sub_u32 s8, s52, 1
    s_sub_u32 s6, s60, 1
    s_bfe_u32 s6, s6, 0x20003
    s_sub_u32 s4, s52, 2
    s_cmp_eq_u32 s16, 0
    s_cselect_b32 s5, 4, 2
    s_sub_u32 s5, s52, s5
    s_nop 3
    s_cmp_eq_u32 s8, 0
    s_cbranch_scc1 K_last
K_loop:
    v_mfma_f32_32x32x16_bf16 v[32:47], v[96:99], v[124:127], v[32:47]
    v_exp_f32 v80, v48
    v_exp_f32 v81, v49
    v_exp_f32 v82, v50
    v_mfma_f32_32x32x16_bf16 v[32:47], v[100:103], v[128:131], v[32:47]
    v_exp_f32 v83, v51
    v_exp_f32 v84, v52
    v_exp_f32 v85, v53
    v_mfma_f32_32x32x16_bf16 v[64:79], v[116:119], v[140:143], 0
    v_exp_f32 v86, v54
    v_exp_f32 v87, v55
    v_exp_f32 v88, v56
    v_mfma_f32_32x32x16_bf16 v[64:79], v[120:123], v[144:147], v[64:79]
    v_exp_f32 v89, v57
    v_exp_f32 v90, v58
    v_exp_f32 v91, v59
    v_exp_f32 v92, v60
    v_exp_f32 v93, v61
    v_exp_f32 v94, v62
    v_exp_f32 v95, v63
    ds_read_b128 v[104:107], v4 offset:64
    ds_read_b128 v[108:111], v5 offset:64
    ds_read_b128 v[10:13], v3 offset:256
    ds_read_b32 v14, v6 offset:256
    ds_read_b64_tr_b16 v[124:125], v2 offset:0
    ds_read_b64_tr_b16 v[126:127], v2 offset:128
    ds_read_b64_tr_b16 v[128:129], v2 offset:256
    ds_read_b64_tr_b16 v[130:131], v2 offset:384
    ds_read_b128 v[116:119], v1 offset:512
    ds_read_b128 v[120:123], v1 offset:7168
    s_cmp_lt_i32 s53, s4
    v_pk_add_f32 v[80:81], v[80:81], 1.0 op_sel_hi:[1,0]
    s_cselect_b32 s26, 5124096, 0
    s_cselect_b32 s34, 160000, 0
    s_cmp_lt_i32 s53, s5
    s_cbranch_scc1 L_pr0
    s_setprio 0
L_pr0:
    v_pk_add_f32 v[82:83], v[82:83], 1.0 op_sel_hi:[1,0]
    v_pk_add_f32 v[84:85], v[84:85], 1.0 op_sel_hi:[1,0]
    v_pk_add_f32 v[86:87], v[86:87], 1.0 op_sel_hi:[1,0]
    v_pk_add_f32 v[88:89], v[88:89], 1.0 op_sel_hi:[1,0]
    v_pk_add_f32 v[90:91], v[90:91], 1.0 op_sel_hi:[1,0]
    v_pk_add_f32 v[92:93], v[92:93], 1.0 op_sel_hi:[1,0]
    v_pk_add_f32 v[94:95], v[94:95], 1.0 op_sel_hi:[1,0]
    v_mfma_f32_32x32x16_bf16 v[64:79], v[112:115], v[152:155], v[64:79]
    v_rcp_f32 v80, v80
    v_rcp_f32 v81, v81
    v_rcp_f32 v82, v82
    s_waitcnt lgkmcnt(0)
    v_mfma_f32_32x32x16_bf16 v[64:79], v[104:107], v[156:159], v[64:79]
    v_rcp_f32 v83, v83
    v_rcp_f32 v84, v84
    v_rcp_f32 v85, v85
    v_mfma_f32_32x32x16_bf16 v[64:79], v[108:111], v[160:163], v[64:79]
    v_rcp_f32 v86, v86
    v_rcp_f32 v87, v87
    v_rcp_f32 v88, v88
    v_rcp_f32 v89, v89
    v_rcp_f32 v90, v90
    v_rcp_f32 v91, v91
    v_rcp_f32 v92, v92
    v_rcp_f32 v93, v93
    v_rcp_f32 v94, v94
    v_add_u32 v10, v253, v10
    v_add_u32 v11, v253, v11
    v_add_u32 v12, v253, v12
    v_add_u32 v13, v253, v13
    s_add_u32 m0, s18, 0
    v_rcp_f32 v95, v95
    buffer_load_dwordx4 v10, s[24:27], s20 offen offset:0 sc1 lds
    buffer_load_dwordx4 v11, s[24:27], s21 offen offset:1088 sc1 lds
    buffer_load_dwordx4 v12, s[24:27], s22 offen offset:2176 sc1 lds
    buffer_load_dwordx4 v13, s[24:27], s23 offen offset:3264 sc1 lds
    s_add_u32 m0, s18, 4288
    v_pk_mul_f32 v[80:81], v[80:81], v[48:49]
    buffer_load_dwordx4 v[14:15], s[32:35], 0 idxen offen lds
    v_pk_mul_f32 v[82:83], v[82:83], v[50:51]
    v_pk_mul_f32 v[84:85], v[84:85], v[52:53]
    v_pk_mul_f32 v[86:87], v[86:87], v[54:55]
    v_pk_mul_f32 v[88:89], v[88:89], v[56:57]
    v_pk_mul_f32 v[90:91], v[90:91], v[58:59]
    v_pk_mul_f32 v[92:93], v[92:93], v[60:61]
    v_pk_mul_f32 v[94:95], v[94:95], v[62:63]
    v_cvt_pk_bf16_f32 v96, v80, v81
    v_cvt_pk_bf16_f32 v97, v82, v83
    v_cvt_pk_bf16_f32 v98, v84, v85
    v_cvt_pk_bf16_f32 v99, v86, v87
    v_cvt_pk_bf16_f32 v100, v88, v89
    v_cvt_pk_bf16_f32 v101, v90, v91
    v_cvt_pk_bf16_f32 v102, v92, v93
    v_cvt_pk_bf16_f32 v103, v94, v95
    v_mfma_f32_32x32x16_bf16 v[16:31], v[96:99], v[124:127], v[16:31]
    v_exp_f32 v80, v64
    v_exp_f32 v81, v65
    v_exp_f32 v82, v66
    v_mfma_f32_32x32x16_bf16 v[16:31], v[100:103], v[128:131], v[16:31]
    v_exp_f32 v83, v67
    v_exp_f32 v84, v68
    v_exp_f32 v85, v69
    v_mfma_f32_32x32x16_bf16 v[48:63], v[116:119], v[132:135], 0
    v_exp_f32 v86, v70
    v_exp_f32 v87, v71
    v_exp_f32 v88, v72
    v_mfma_f32_32x32x16_bf16 v[48:63], v[120:123], v[136:139], v[48:63]
    v_exp_f32 v89, v73
    v_exp_f32 v90, v74
    v_exp_f32 v91, v75
    v_exp_f32 v92, v76
    v_exp_f32 v93, v77
    v_exp_f32 v94, v78
    v_exp_f32 v95, v79
    s_waitcnt vmcnt(5)
    ds_read_b128 v[112:115], v8 offset:9600
    ds_read_b128 v[104:107], v4 offset:5312
    ds_read_b128 v[108:111], v5 offset:5312
    s_add_u32 s53, s53, 1
    v_pk_add_f32 v[80:81], v[80:81], 1.0 op_sel_hi:[1,0]
    s_cmp_ge_u32 s53, s8
    v_pk_add_f32 v[82:83], v[82:83], 1.0 op_sel_hi:[1,0]
    v_pk_add_f32 v[84:85], v[84:85], 1.0 op_sel_hi:[1,0]
    v_pk_add_f32 v[86:87], v[86:87], 1.0 op_sel_hi:[1,0]
    v_pk_add_f32 v[88:89], v[88:89], 1.0 op_sel_hi:[1,0]
    v_pk_add_f32 v[90:91], v[90:91], 1.0 op_sel_hi:[1,0]
    v_pk_add_f32 v[92:93], v[92:93], 1.0 op_sel_hi:[1,0]
    v_pk_add_f32 v[94:95], v[94:95], 1.0 op_sel_hi:[1,0]
    s_waitcnt lgkmcnt(0)
    v_mfma_f32_32x32x16_bf16 v[48:63], v[112:115], v[148:151], v[48:63]
    v_rcp_f32 v80, v80
    v_rcp_f32 v81, v81
    v_rcp_f32 v82, v82
    v_mfma_f32_32x32x16_bf16 v[48:63], v[104:107], v[156:159], v[48:63]
    v_rcp_f32 v83, v83
    v_rcp_f32 v84, v84
    v_rcp_f32 v85, v85
    v_mfma_f32_32x32x16_bf16 v[48:63], v[108:111], v[160:163], v[48:63]
    v_rcp_f32 v86, v86
    v_rcp_f32 v87, v87
    v_rcp_f32 v88, v88
    v_rcp_f32 v89, v89
    v_rcp_f32 v90, v90
    v_rcp_f32 v91, v91
    v_rcp_f32 v92, v92
    v_rcp_f32 v93, v93
    v_rcp_f32 v94, v94
    v_rcp_f32 v95, v95
    v_pk_mul_f32 v[80:81], v[80:81], v[64:65]
    v_pk_mul_f32 v[82:83], v[82:83], v[66:67]
    v_pk_mul_f32 v[84:85], v[84:85], v[68:69]
    v_pk_mul_f32 v[86:87], v[86:87], v[70:71]
    v_pk_mul_f32 v[88:89], v[88:89], v[72:73]
    v_pk_mul_f32 v[90:91], v[90:91], v[74:75]
    v_pk_mul_f32 v[92:93], v[92:93], v[76:77]
    v_pk_mul_f32 v[94:95], v[94:95], v[78:79]
    v_cvt_pk_bf16_f32 v96, v80, v81
    v_cvt_pk_bf16_f32 v97, v82, v83
    v_cvt_pk_bf16_f32 v98, v84, v85
    v_cvt_pk_bf16_f32 v99, v86, v87
    v_cvt_pk_bf16_f32 v100, v88, v89
    v_cvt_pk_bf16_f32 v101, v90, v91
    v_cvt_pk_bf16_f32 v102, v92, v93
    v_cvt_pk_bf16_f32 v103, v94, v95
    s_cbranch_scc1 K_odd
    v_mfma_f32_32x32x16_bf16 v[32:47], v[96:99], v[124:127], v[32:47]
    v_exp_f32 v80, v48
    v_exp_f32 v81, v49
    v_exp_f32 v82, v50
    v_mfma_f32_32x32x16_bf16 v[32:47], v[100:103], v[128:131], v[32:47]
    v_exp_f32 v83, v51
    v_exp_f32 v84, v52
    v_exp_f32 v85, v53
    v_mfma_f32_32x32x16_bf16 v[64:79], v[116:119], v[140:143], 0
    v_exp_f32 v86, v54
    v_exp_f32 v87, v55
    v_exp_f32 v88, v56
    v_mfma_f32_32x32x16_bf16 v[64:79], v[120:123], v[144:147], v[64:79]
    v_exp_f32 v89, v57
    v_exp_f32 v90, v58
    v_exp_f32 v91, v59
    v_exp_f32 v92, v60
    v_exp_f32 v93, v61
    v_exp_f32 v94, v62
    v_exp_f32 v95, v63
    ds_read_b128 v[104:107], v4 offset:5376
    ds_read_b128 v[108:111], v5 offset:5376
    ds_read_b128 v[10:13], v3 offset:384
    ds_read_b32 v14, v6 offset:384
    ds_read_b64_tr_b16 v[124:125], v2 offset:512
    ds_read_b64_tr_b16 v[126:127], v2 offset:640
    ds_read_b64_tr_b16 v[128:129], v2 offset:768
    ds_read_b64_tr_b16 v[130:131], v2 offset:896
    ds_read_b128 v[116:119], v1 offset:1024
    ds_read_b128 v[120:123], v1 offset:7680
    s_cmp_lt_i32 s53, s4
    v_pk_add_f32 v[80:81], v[80:81], 1.0 op_sel_hi:[1,0]
    s_cselect_b32 s26, 5124096, 0
    s_cselect_b32 s34, 160000, 0
    s_cmp_lt_i32 s53, s5
    s_cbranch_scc1 L_pr1
    s_setprio 0
L_pr1:
    v_pk_add_f32 v[82:83], v[82:83], 1.0 op_sel_hi:[1,0]
    v_pk_add_f32 v[84:85], v[84:85], 1.0 op_sel_hi:[1,0]
    v_pk_add_f32 v[86:87], v[86:87], 1.0 op_sel_hi:[1,0]
    v_pk_add_f32 v[88:89], v[88:89], 1.0 op_sel_hi:[1,0]
    v_pk_add_f32 v[90:91], v[90:91], 1.0 op_sel_hi:[1,0]
    v_pk_add_f32 v[92:93], v[92:93], 1.0 op_sel_hi:[1,0]
    v_pk_add_f32 v[94:95], v[94:95], 1.0 op_sel_hi:[1,0]
    v_mfma_f32_32x32x16_bf16 v[64:79], v[112:115], v[152:155], v[64:79]
    v_rcp_f32 v80, v80
    v_rcp_f32 v81, v81
    v_rcp_f32 v82, v82
    s_waitcnt lgkmcnt(0)
    v_mfma_f32_32x32x16_bf16 v[64:79], v[104:107], v[156:159], v[64:79]
    v_rcp_f32 v83, v83
    v_rcp_f32 v84, v84
    v_rcp_f32 v85, v85
    v_mfma_f32_32x32x16_bf16 v[64:79], v[108:111], v[160:163], v[64:79]
    v_rcp_f32 v86, v86
    v_rcp_f32 v87, v87
    v_rcp_f32 v88, v88
    v_rcp_f32 v89, v89
    v_rcp_f32 v90, v90
    v_rcp_f32 v91, v91
    v_rcp_f32 v92, v92
    v_rcp_f32 v93, v93
    v_rcp_f32 v94, v94
    v_add_u32 v10, v253, v10
    v_add_u32 v11, v253, v11
    v_add_u32 v12, v253, v12
    v_add_u32 v13, v253, v13
    s_add_u32 m0, s18, 5312
    v_rcp_f32 v95, v95
    buffer_load_dwordx4 v10, s[24:27], s20 offen offset:0 sc1 lds
    buffer_load_dwordx4 v11, s[24:27], s21 offen offset:1088 sc1 lds
    buffer_load_dwordx4 v12, s[24:27], s22 offen offset:2176 sc1 lds
    buffer_load_dwordx4 v13, s[24:27], s23 offen offset:3264 sc1 lds
    s_add_u32 m0, s18, 9600
    v_pk_mul_f32 v[80:81], v[80:81], v[48:49]
    buffer_load_dwordx4 v[14:15], s[32:35], 0 idxen offen lds
    v_pk_mul_f32 v[82:83], v[82:83], v[50:51]
    v_pk_mul_f32 v[84:85], v[84:85], v[52:53]
    v_pk_mul_f32 v[86:87], v[86:87], v[54:55]
    v_pk_mul_f32 v[88:89], v[88:89], v[56:57]
    v_pk_mul_f32 v[90:91], v[90:91], v[58:59]
    v_pk_mul_f32 v[92:93], v[92:93], v[60:61]
    v_pk_mul_f32 v[94:95], v[94:95], v[62:63]
    v_cvt_pk_bf16_f32 v96, v80, v81
    v_cvt_pk_bf16_f32 v97, v82, v83
    v_cvt_pk_bf16_f32 v98, v84, v85
    v_cvt_pk_bf16_f32 v99, v86, v87
    v_cvt_pk_bf16_f32 v100, v88, v89
    v_cvt_pk_bf16_f32 v101, v90, v91
    v_cvt_pk_bf16_f32 v102, v92, v93
    v_cvt_pk_bf16_f32 v103, v94, v95
    v_mfma_f32_32x32x16_bf16 v[16:31], v[96:99], v[124:127], v[16:31]
    v_exp_f32 v80, v64
    v_exp_f32 v81, v65
    v_exp_f32 v82, v66
    v_mfma_f32_32x32x16_bf16 v[16:31], v[100:103], v[128:131], v[16:31]
    v_exp_f32 v83, v67
    v_exp_f32 v84, v68
    v_exp_f32 v85, v69
    v_mfma_f32_32x32x16_bf16 v[48:63], v[116:119], v[132:135], 0
    v_exp_f32 v86, v70
    v_exp_f32 v87, v71
    v_exp_f32 v88, v72
    v_mfma_f32_32x32x16_bf16 v[48:63], v[120:123], v[136:139], v[48:63]
    v_exp_f32 v89, v73
    v_exp_f32 v90, v74
    v_exp_f32 v91, v75
    v_exp_f32 v92, v76
    v_exp_f32 v93, v77
    v_exp_f32 v94, v78
    v_exp_f32 v95, v79
    s_waitcnt vmcnt(5)
    ds_read_b128 v[112:115], v8 offset:4288
    ds_read_b128 v[104:107], v4 offset:0
    ds_read_b128 v[108:111], v5 offset:0
    s_cmp_lt_u32 s9, 4
    s_cbranch_scc1 L_wu
L_wub:
    s_add_u32 s53, s53, 1
    v_pk_add_f32 v[80:81], v[80:81], 1.0 op_sel_hi:[1,0]
    s_cmp_ge_u32 s53, s8
    v_pk_add_f32 v[82:83], v[82:83], 1.0 op_sel_hi:[1,0]
    v_pk_add_f32 v[84:85], v[84:85], 1.0 op_sel_hi:[1,0]
    v_pk_add_f32 v[86:87], v[86:87], 1.0 op_sel_hi:[1,0]
    v_pk_add_f32 v[88:89], v[88:89], 1.0 op_sel_hi:[1,0]
    v_pk_add_f32 v[90:91], v[90:91], 1.0 op_sel_hi:[1,0]
    v_pk_add_f32 v[92:93], v[92:93], 1.0 op_sel_hi:[1,0]
    v_pk_add_f32 v[94:95], v[94:95], 1.0 op_sel_hi:[1,0]
    s_waitcnt lgkmcnt(0)
    v_mfma_f32_32x32x16_bf16 v[48:63], v[112:115], v[148:151], v[48:63]
    v_rcp_f32 v80, v80
    v_rcp_f32 v81, v81
    v_rcp_f32 v82, v82
    v_mfma_f32_32x32x16_bf16 v[48:63], v[104:107], v[156:159], v[48:63]
    v_rcp_f32 v83, v83
    v_rcp_f32 v84, v84
    v_rcp_f32 v85, v85
    v_mfma_f32_32x32x16_bf16 v[48:63], v[108:111], v[160:163], v[48:63]
    v_rcp_f32 v86, v86
    v_rcp_f32 v87, v87
    v_rcp_f32 v88, v88
    v_rcp_f32 v89, v89
    v_rcp_f32 v90, v90
    v_rcp_f32 v91, v91
    v_rcp_f32 v92, v92
    v_rcp_f32 v93, v93
    v_rcp_f32 v94, v94
    v_rcp_f32 v95, v95
    v_pk_mul_f32 v[80:81], v[80:81], v[64:65]
    v_pk_mul_f32 v[82:83], v[82:83], v[66:67]
    v_pk_mul_f32 v[84:85], v[84:85], v[68:69]
    v_pk_mul_f32 v[86:87], v[86:87], v[70:71]
    v_pk_mul_f32 v[88:89], v[88:89], v[72:73]
    v_pk_mul_f32 v[90:91], v[90:91], v[74:75]
    v_pk_mul_f32 v[92:93], v[92:93], v[76:77]
    v_pk_mul_f32 v[94:95], v[94:95], v[78:79]
    v_add_u32 v1, 1024, v1
    v_add_u32 v2, 1024, v2
    v_add_u32 v3, 256, v3
    v_add_u32 v6, 256, v6
    v_cvt_pk_bf16_f32 v96, v80, v81
    v_cvt_pk_bf16_f32 v97, v82, v83
    v_cvt_pk_bf16_f32 v98, v84, v85
    v_cvt_pk_bf16_f32 v99, v86, v87
    v_cvt_pk_bf16_f32 v100, v88, v89
    v_cvt_pk_bf16_f32 v101, v90, v91
    v_cvt_pk_bf16_f32 v102, v92, v93
    v_cvt_pk_bf16_f32 v103, v94, v95
    s_cbranch_scc0 K_loop
K_last:
    s_cmp_eq_u32 s6, 0
    s_cbranch_scc1 K_l0
    s_cmp_eq_u32 s6, 1
    s_cbranch_scc1 K_l1
    s_cmp_eq_u32 s6, 2
    s_cbranch_scc1 K_l2
    ds_read_b128 v[104:107], v4 offset:64
    ds_read_b128 v[108:111], v5 offset:64
    v_mfma_f32_32x32x16_bf16 v[32:47], v[96:99], v[124:127], v[32:47]
    v_exp_f32 v80, v48
    v_exp_f32 v81, v49
    v_exp_f32 v82, v50
    v_mfma_f32_32x32x16_bf16 v[32:47], v[100:103], v[128:131], v[32:47]
    v_exp_f32 v83, v51
    v_exp_f32 v84, v52
    v_exp_f32 v85, v53
    v_mfma_f32_32x32x16_bf16 v[64:79], v[116:119], v[140:143], 0
    ds_read_b64_tr_b16 v[124:125], v2 offset:0
    ds_read_b64_tr_b16 v[126:127], v2 offset:128
    ds_read_b64_tr_b16 v[128:129], v2 offset:256
    ds_read_b64_tr_b16 v[130:131], v2 offset:384
    v_exp_f32 v86, v54
    v_exp_f32 v87, v55
    v_exp_f32 v88, v56
    v_mfma_f32_32x32x16_bf16 v[64:79], v[120:123], v[144:147], v[64:79]
    v_exp_f32 v89, v57
    v_exp_f32 v90, v58
    v_exp_f32 v91, v59
    v_mfma_f32_32x32x16_bf16 v[64:79], v[112:115], v[152:155], v[64:79]
    v_exp_f32 v92, v60
    v_exp_f32 v93, v61
    v_exp_f32 v94, v62
    v_exp_f32 v95, v63
    v_pk_add_f32 v[80:81], v[80:81], 1.0 op_sel_hi:[1,0]
    v_pk_add_f32 v[82:83], v[82:83], 1.0 op_sel_hi:[1,0]
    v_pk_add_f32 v[84:85], v[84:85], 1.0 op_sel_hi:[1,0]
    v_pk_add_f32 v[86:87], v[86:87], 1.0 op_sel_hi:[1,0]
    v_pk_add_f32 v[88:89], v[88:89], 1.0 op_sel_hi:[1,0]
    v_pk_add_f32 v[90:91], v[90:91], 1.0 op_sel_hi:[1,0]
    v_pk_add_f32 v[92:93], v[92:93], 1.0 op_sel_hi:[1,0]
    v_pk_add_f32 v[94:95], v[94:95], 1.0 op_sel_hi:[1,0]
    s_waitcnt lgkmcnt(4)
    v_mfma_f32_32x32x16_bf16 v[64:79], v[104:107], v[156:159], v[64:79]
    v_rcp_f32 v80, v80
    v_rcp_f32 v81, v81
    v_rcp_f32 v82, v82
    v_mfma_f32_32x32x16_bf16 v[64:79], v[108:111], v[160:163], v[64:79]
    v_rcp_f32 v83, v83
    v_rcp_f32 v84, v84
    v_rcp_f32 v85, v85
    v_rcp_f32 v86, v86
    v_rcp_f32 v87, v87
    v_rcp_f32 v88, v88
    v_rcp_f32 v89, v89
    v_rcp_f32 v90, v90
    v_rcp_f32 v91, v91
    v_rcp_f32 v92, v92
    v_rcp_f32 v93, v93
    v_rcp_f32 v94, v94
    v_rcp_f32 v95, v95
    v_pk_mul_f32 v[80:81], v[80:81], v[48:49]
    v_pk_mul_f32 v[82:83], v[82:83], v[50:51]
    v_pk_mul_f32 v[84:85], v[84:85], v[52:53]
    v_pk_mul_f32 v[86:87], v[86:87], v[54:55]
    v_pk_mul_f32 v[88:89], v[88:89], v[56:57]
    v_pk_mul_f32 v[90:91], v[90:91], v[58:59]
    v_pk_mul_f32 v[92:93], v[92:93], v[60:61]
    v_pk_mul_f32 v[94:95], v[94:95], v[62:63]
    v_cvt_pk_bf16_f32 v96, v80, v81
    v_cvt_pk_bf16_f32 v97, v82, v83
    v_cvt_pk_bf16_f32 v98, v84, v85
    v_cvt_pk_bf16_f32 v99, v86, v87
    v_cvt_pk_bf16_f32 v100, v88, v89
    v_cvt_pk_bf16_f32 v101, v90, v91
    v_cvt_pk_bf16_f32 v102, v92, v93
    v_cvt_pk_bf16_f32 v103, v94, v95
    s_waitcnt lgkmcnt(0)
    v_mfma_f32_32x32x16_bf16 v[16:31], v[96:99], v[124:127], v[16:31]
    v_exp_f32 v80, v64
    v_exp_f32 v81, v65
    v_exp_f32 v82, v66
    v_mfma_f32_32x32x16_bf16 v[16:31], v[100:103], v[128:131], v[16:31]
    v_exp_f32 v83, v67
    v_exp_f32 v84, v68
    v_exp_f32 v85, v69
    v_exp_f32 v86, v70
    v_exp_f32 v87, v71
    v_exp_f32 v88, v72
    v_exp_f32 v89, v73
    v_exp_f32 v90, v74
    v_exp_f32 v91, v75
    v_exp_f32 v92, v76
    v_exp_f32 v93, v77
    v_exp_f32 v94, v78
    v_exp_f32 v95, v79
    v_pk_add_f32 v[80:81], v[80:81], 1.0 op_sel_hi:[1,0]
    v_pk_add_f32 v[82:83], v[82:83], 1.0 op_sel_hi:[1,0]
    v_pk_add_f32 v[84:85], v[84:85], 1.0 op_sel_hi:[1,0]
    v_pk_add_f32 v[86:87], v[86:87], 1.0 op_sel_hi:[1,0]
    v_pk_add_f32 v[88:89], v[88:89], 1.0 op_sel_hi:[1,0]
    v_pk_add_f32 v[90:91], v[90:91], 1.0 op_sel_hi:[1,0]
    v_pk_add_f32 v[92:93], v[92:93], 1.0 op_sel_hi:[1,0]
    v_pk_add_f32 v[94:95], v[94:95], 1.0 op_sel_hi:[1,0]
    v_rcp_f32 v80, v80
    v_rcp_f32 v81, v81
    v_rcp_f32 v82, v82
    v_rcp_f32 v83, v83
    v_rcp_f32 v84, v84
    v_rcp_f32 v85, v85
    v_rcp_f32 v86, v86
    v_rcp_f32 v87, v87
    v_rcp_f32 v88, v88
    v_rcp_f32 v89, v89
    v_rcp_f32 v90, v90
    v_rcp_f32 v91, v91
    v_rcp_f32 v92, v92
    v_rcp_f32 v93, v93
    v_rcp_f32 v94, v94
    v_rcp_f32 v95, v95
    v_pk_mul_f32 v[80:81], v[80:81], v[64:65]
    v_pk_mul_f32 v[82:83], v[82:83], v[66:67]
    v_pk_mul_f32 v[84:85], v[84:85], v[68:69]
    v_pk_mul_f32 v[86:87], v[86:87], v[70:71]
    v_pk_mul_f32 v[88:89], v[88:89], v[72:73]
    v_pk_mul_f32 v[90:91], v[90:91], v[74:75]
    v_pk_mul_f32 v[92:93], v[92:93], v[76:77]
    v_pk_mul_f32 v[94:95], v[94:95], v[78:79]
    v_cvt_pk_bf16_f32 v96, v80, v81
    v_cvt_pk_bf16_f32 v97, v82, v83
    v_cvt_pk_bf16_f32 v98, v84, v85
    v_cvt_pk_bf16_f32 v99, v86, v87
    v_cvt_pk_bf16_f32 v100, v88, v89
    v_cvt_pk_bf16_f32 v101, v90, v91
    v_cvt_pk_bf16_f32 v102, v92, v93
    v_cvt_pk_bf16_f32 v103, v94, v95
K_lend:
    s_nop 1
    v_mfma_f32_32x32x16_bf16 v[32:47], v[96:99], v[124:127], v[32:47]
    v_mfma_f32_32x32x16_bf16 v[32:47], v[100:103], v[128:131], v[32:47]
K_rend:
    s_mov_b32 s13, 0
    s_add_u32 s54, s54, 416
    s_cmp_lt_u32 s54, s55
    s_cbranch_scc1 K_again
    s_or_b32 s61, s56, s57
    s_cbranch_scc0 K_final
    s_mov_b32 s54, 0
    s_add_u32 s58, s58, 1
    s_cmp_lt_u32 s58, 5
    s_cbranch_scc1 K_samech
    s_bitset0_b32 s56, s59
    s_bitset0_b32 s57, s59
    s_mov_b32 s58, 0
    s_or_b32 s61, s56, s57
    s_cbranch_scc0 K_final
K_samech:
    s_ff1_i32_b32 s59, s61
K_again:
    s_nop 7
    s_nop 7
    s_waitcnt vmcnt(0) lgkmcnt(0)
    s_barrier
    s_cmp_eq_u32 s52, 0
    s_cbranch_scc1 K_noadj
    s_bitcmp1_b32 s52, 0
    s_cbranch_scc1 K_noadj
    v_subrev_u32 v4, 5312, v4
    v_subrev_u32 v5, 5312, v5
K_noadj:
    v_mov_b32 v56, 0
    v_mov_b32 v57, 0
    v_mov_b32 v58, 0
    v_mov_b32 v59, 0
    v_lshlrev_b32 v60, 4, v0
    v_add_u32 v60, 84992, v60
    ds_write_b128 v60, v[56:59] offset:0
    ds_write_b128 v60, v[56:59] offset:8192
    ds_write_b128 v60, v[56:59] offset:16384
    ds_write_b128 v60, v[56:59] offset:24576
    ds_write_b128 v60, v[56:59] offset:32768
    ds_write_b128 v60, v[56:59] offset:40960
    v_mul_u32_u24 v52, 6656, v254
    v_and_b32 v53, 31, v9
    v_lshl_add_u32 v52, v53, 4, v52
    v_add_u32 v1, s15, v52
    s_add_u32 s61, s15, 19968
    v_lshrrev_b32 v52, 3, v9
    v_lshl_add_u32 v3, v52, 4, s61
    v_lshrrev_b32 v52, 1, v9
    v_lshl_add_u32 v6, v52, 2, s61
    v_add_u32 v6, 1664, v6
    v_bfe_u32 v52, v9, 4, 1
    v_bfe_u32 v53, v9, 1, 1
    v_lshl_add_u32 v52, v52, 1, v53
    v_mul_u32_u24 v52, 6656, v52
    v_bfe_u32 v53, v9, 2, 2
    v_lshl_add_u32 v53, v254, 2, v53
    v_lshl_add_u32 v52, v53, 4, v52
    v_and_b32 v53, 1, v9
    v_lshl_add_u32 v52, v53, 3, v52
    v_add_u32 v2, s15, v52
    s_waitcnt lgkmcnt(0)
    s_barrier
    s_cmp_lg_u32 s58, -1
    s_cbranch_scc1 K_raw
    buffer_load_dwordx4 v[128:131], v7, s[28:31], s14 offen sc1
    s_waitcnt vmcnt(0)
    s_branch K_havrec
K_raw:
    s_mul_i32 s61, s59, 20000
    s_lshl_b32 s94, s58, 12
    s_add_u32 s61, s61, s94
    buffer_load_dwordx4 v[128:131], v7, s[44:47], s61 offen
    buffer_load_dwordx4 v[64:67], v7, s[48:51], s61 offen
    s_mul_i32 s95, s59, 5000
    v_mov_b32 v255, s95
    s_cmp_eq_u32 s16, 0
    s_cselect_b32 s95, s56, s57
    s_bitcmp1_b32 s95, s59
    s_cselect_b32 s95, s19, -1
    v_add_u32 v68, s94, v7
    v_lshrrev_b32 v68, 2, v68
    s_movk_i32 s96, 5000
    v_cmp_gt_u32 s[62:63], s96, v68
    s_waitcnt vmcnt(0)
    v_and_b32 v69, 0x1ff, v64
    v_cmp_eq_u32 vcc, s95, v69
    v_lshrrev_b32 v69, 9, v64
    v_lshl_or_b32 v128, v69, 14, v128
    v_add_u32 v69, 0, v68
    v_lshl_or_b32 v128, v69, 19, v128
    s_and_b64 vcc, vcc, s[62:63]
    v_cndmask_b32 v128, -1, v128, vcc
    v_and_b32 v69, 0x1ff, v65
    v_cmp_eq_u32 vcc, s95, v69
    v_lshrrev_b32 v69, 9, v65
    v_lshl_or_b32 v129, v69, 14, v129
    v_add_u32 v69, 1, v68
    v_lshl_or_b32 v129, v69, 19, v129
    s_and_b64 vcc, vcc, s[62:63]
    v_cndmask_b32 v129, -1, v129, vcc
    v_and_b32 v69, 0x1ff, v66
    v_cmp_eq_u32 vcc, s95, v69
    v_lshrrev_b32 v69, 9, v66
    v_lshl_or_b32 v130, v69, 14, v130
    v_add_u32 v69, 2, v68
    v_lshl_or_b32 v130, v69, 19, v130
    s_and_b64 vcc, vcc, s[62:63]
    v_cndmask_b32 v130, -1, v130, vcc
    v_and_b32 v69, 0x1ff, v67
    v_cmp_eq_u32 vcc, s95, v69
    v_lshrrev_b32 v69, 9, v67
    v_lshl_or_b32 v131, v69, 14, v131
    v_add_u32 v69, 3, v68
    v_lshl_or_b32 v131, v69, 19, v131
    s_and_b64 vcc, vcc, s[62:63]
    v_cndmask_b32 v131, -1, v131, vcc
    s_branch K_havrec
K_odd:
    v_add_u32 v4, 5312, v4
    v_add_u32 v5, 5312, v5
    v_add_u32 v2, 512, v2
    s_branch K_last
K_l0:
    ds_read_b128 v[104:107], v4 offset:64
    ds_read_b128 v[108:111], v5 offset:64
    v_mfma_f32_32x32x16_bf16 v[32:47], v[96:99], v[124:127], v[32:47]
    v_exp_f32 v80, v48
    v_mfma_f32_32x32x16_bf16 v[32:47], v[100:103], v[128:131], v[32:47]
    v_exp_f32 v81, v49
    v_mfma_f32_32x32x16_bf16 v[64:79], v[116:119], v[140:143], 0
    ds_read_b64_tr_b16 v[124:125], v2 offset:0
    ds_read_b64_tr_b16 v[126:127], v2 offset:128
    ds_read_b64_tr_b16 v[128:129], v2 offset:256
    ds_read_b64_tr_b16 v[130:131], v2 offset:384
    v_exp_f32 v82, v50
    v_mfma_f32_32x32x16_bf16 v[64:79], v[120:123], v[144:147], v[64:79]
    v_exp_f32 v83, v51
    v_pk_add_f32 v[80:81], v[80:81], 1.0 op_sel_hi:[1,0]
    v_pk_add_f32 v[82:83], v[82:83], 1.0 op_sel_hi:[1,0]
    v_mfma_f32_32x32x16_bf16 v[64:79], v[112:115], v[152:155], v[64:79]
    v_rcp_f32 v80, v80
    s_waitcnt lgkmcnt(4)
    v_mfma_f32_32x32x16_bf16 v[64:79], v[104:107], v[156:159], v[64:79]
    v_rcp_f32 v81, v81
    v_mfma_f32_32x32x16_bf16 v[64:79], v[108:111], v[160:163], v[64:79]
    v_rcp_f32 v82, v82
    v_rcp_f32 v83, v83
    v_pk_mul_f32 v[80:81], v[80:81], v[48:49]
    v_pk_mul_f32 v[82:83], v[82:83], v[50:51]
    v_cvt_pk_bf16_f32 v96, v80, v81
    v_cvt_pk_bf16_f32 v97, v82, v83
    v_mov_b32 v98, 0
    v_mov_b32 v99, 0
    v_mov_b32 v100, 0
    v_mov_b32 v101, 0
    v_mov_b32 v102, 0
    v_mov_b32 v103, 0
    s_waitcnt lgkmcnt(0)
    s_nop 7
    v_mfma_f32_32x32x16_bf16 v[16:31], v[96:99], v[124:127], v[16:31]
    v_exp_f32 v80, v64
    v_exp_f32 v81, v65
    v_exp_f32 v82, v66
    v_exp_f32 v83, v67
    v_pk_add_f32 v[80:81], v[80:81], 1.0 op_sel_hi:[1,0]
    v_pk_add_f32 v[82:83], v[82:83], 1.0 op_sel_hi:[1,0]
    v_rcp_f32 v80, v80
    v_rcp_f32 v81, v81
    v_rcp_f32 v82, v82
    v_rcp_f32 v83, v83
    v_pk_mul_f32 v[80:81], v[80:81], v[64:65]
    v_pk_mul_f32 v[82:83], v[82:83], v[66:67]
    v_cvt_pk_bf16_f32 v96, v80, v81
    v_cvt_pk_bf16_f32 v97, v82, v83
    s_branch K_lend
K_l1:
    ds_read_b128 v[104:107], v4 offset:64
    ds_read_b128 v[108:111], v5 offset:64
    v_mfma_f32_32x32x16_bf16 v[32:47], v[96:99], v[124:127], v[32:47]
    v_exp_f32 v80, v48
    v_exp_f32 v81, v49
    v_mfma_f32_32x32x16_bf16 v[32:47], v[100:103], v[128:131], v[32:47]
    v_exp_f32 v82, v50
    v_exp_f32 v83, v51
    v_mfma_f32_32x32x16_bf16 v[64:79], v[116:119], v[140:143], 0
    ds_read_b64_tr_b16 v[124:125], v2 offset:0
    ds_read_b64_tr_b16 v[126:127], v2 offset:128
    ds_read_b64_tr_b16 v[128:129], v2 offset:256
    ds_read_b64_tr_b16 v[130:131], v2 offset:384
    v_exp_f32 v84, v52
    v_exp_f32 v85, v53
    v_mfma_f32_32x32x16_bf16 v[64:79], v[120:123], v[144:147], v[64:79]
    v_exp_f32 v86, v54
    v_exp_f32 v87, v55
    v_pk_add_f32 v[80:81], v[80:81], 1.0 op_sel_hi:[1,0]
    v_pk_add_f32 v[82:83], v[82:83], 1.0 op_sel_hi:[1,0]
    v_pk_add_f32 v[84:85], v[84:85], 1.0 op_sel_hi:[1,0]
    v_pk_add_f32 v[86:87], v[86:87], 1.0 op_sel_hi:[1,0]
    v_mfma_f32_32x32x16_bf16 v[64:79], v[112:115], v[152:155], v[64:79]
    v_rcp_f32 v80, v80
    v_rcp_f32 v81, v81
    s_waitcnt lgkmcnt(4)
    v_mfma_f32_32x32x16_bf16 v[64:79], v[104:107], v[156:159], v[64:79]
    v_rcp_f32 v82, v82
    v_rcp_f32 v83, v83
    v_mfma_f32_32x32x16_bf16 v[64:79], v[108:111], v[160:163], v[64:79]
    v_rcp_f32 v84, v84
    v_rcp_f32 v85, v85
    v_rcp_f32 v86, v86
    v_rcp_f32 v87, v87
    v_pk_mul_f32 v[80:81], v[80:81], v[48:49]
    v_pk_mul_f32 v[82:83], v[82:83], v[50:51]
    v_pk_mul_f32 v[84:85], v[84:85], v[52:53]
    v_pk_mul_f32 v[86:87], v[86:87], v[54:55]
    v_cvt_pk_bf16_f32 v96, v80, v81
    v_cvt_pk_bf16_f32 v97, v82, v83
    v_cvt_pk_bf16_f32 v98, v84, v85
    v_cvt_pk_bf16_f32 v99, v86, v87
    v_mov_b32 v100, 0
    v_mov_b32 v101, 0
    v_mov_b32 v102, 0
    v_mov_b32 v103, 0
    s_waitcnt lgkmcnt(0)
    s_nop 7
    v_mfma_f32_32x32x16_bf16 v[16:31], v[96:99], v[124:127], v[16:31]
    v_exp_f32 v80, v64
    v_exp_f32 v81, v65
    v_exp_f32 v82, v66
    v_exp_f32 v83, v67
    v_exp_f32 v84, v68
    v_exp_f32 v85, v69
    v_exp_f32 v86, v70
    v_exp_f32 v87, v71
    v_pk_add_f32 v[80:81], v[80:81], 1.0 op_sel_hi:[1,0]
    v_pk_add_f32 v[82:83], v[82:83], 1.0 op_sel_hi:[1,0]
    v_pk_add_f32 v[84:85], v[84:85], 1.0 op_sel_hi:[1,0]
    v_pk_add_f32 v[86:87], v[86:87], 1.0 op_sel_hi:[1,0]
    v_rcp_f32 v80, v80
    v_rcp_f32 v81, v81
    v_rcp_f32 v82, v82
    v_rcp_f32 v83, v83
    v_rcp_f32 v84, v84
    v_rcp_f32 v85, v85
    v_rcp_f32 v86, v86
    v_rcp_f32 v87, v87
    v_pk_mul_f32 v[80:81], v[80:81], v[64:65]
    v_pk_mul_f32 v[82:83], v[82:83], v[66:67]
    v_pk_mul_f32 v[84:85], v[84:85], v[68:69]
    v_pk_mul_f32 v[86:87], v[86:87], v[70:71]
    v_cvt_pk_bf16_f32 v96, v80, v81
    v_cvt_pk_bf16_f32 v97, v82, v83
    v_cvt_pk_bf16_f32 v98, v84, v85
    v_cvt_pk_bf16_f32 v99, v86, v87
    s_branch K_lend
K_l2:
    ds_read_b128 v[104:107], v4 offset:64
    ds_read_b128 v[108:111], v5 offset:64
    v_mfma_f32_32x32x16_bf16 v[32:47], v[96:99], v[124:127], v[32:47]
    v_exp_f32 v80, v48
    v_exp_f32 v81, v49
    v_exp_f32 v82, v50
    v_mfma_f32_32x32x16_bf16 v[32:47], v[100:103], v[128:131], v[32:47]
    v_exp_f32 v83, v51
    v_exp_f32 v84, v52
    v_exp_f32 v85, v53
    v_mfma_f32_32x32x16_bf16 v[64:79], v[116:119], v[140:143], 0
    ds_read_b64_tr_b16 v[124:125], v2 offset:0
    ds_read_b64_tr_b16 v[126:127], v2 offset:128
    ds_read_b64_tr_b16 v[128:129], v2 offset:256
    ds_read_b64_tr_b16 v[130:131], v2 offset:384
    v_exp_f32 v86, v54
    v_exp_f32 v87, v55
    v_exp_f32 v88, v56
    v_mfma_f32_32x32x16_bf16 v[64:79], v[120:123], v[144:147], v[64:79]
    v_exp_f32 v89, v57
    v_exp_f32 v90, v58
    v_exp_f32 v91, v59
    v_pk_add_f32 v[80:81], v[80:81], 1.0 op_sel_hi:[1,0]
    v_pk_add_f32 v[82:83], v[82:83], 1.0 op_sel_hi:[1,0]
    v_pk_add_f32 v[84:85], v[84:85], 1.0 op_sel_hi:[1,0]
    v_pk_add_f32 v[86:87], v[86:87], 1.0 op_sel_hi:[1,0]
    v_pk_add_f32 v[88:89], v[88:89], 1.0 op_sel_hi:[1,0]
    v_pk_add_f32 v[90:91], v[90:91], 1.0 op_sel_hi:[1,0]
    v_mfma_f32_32x32x16_bf16 v[64:79], v[112:115], v[152:155], v[64:79]
    v_rcp_f32 v80, v80
    v_rcp_f32 v81, v81
    v_rcp_f32 v82, v82
    s_waitcnt lgkmcnt(4)
    v_mfma_f32_32x32x16_bf16 v[64:79], v[104:107], v[156:159], v[64:79]
    v_rcp_f32 v83, v83
    v_rcp_f32 v84, v84
    v_rcp_f32 v85, v85
    v_mfma_f32_32x32x16_bf16 v[64:79], v[108:111], v[160:163], v[64:79]
    v_rcp_f32 v86, v86
    v_rcp_f32 v87, v87
    v_rcp_f32 v88, v88
    v_rcp_f32 v89, v89
    v_rcp_f32 v90, v90
    v_rcp_f32 v91, v91
    v_pk_mul_f32 v[80:81], v[80:81], v[48:49]
    v_pk_mul_f32 v[82:83], v[82:83], v[50:51]
    v_pk_mul_f32 v[84:85], v[84:85], v[52:53]
    v_pk_mul_f32 v[86:87], v[86:87], v[54:55]
    v_pk_mul_f32 v[88:89], v[88:89], v[56:57]
    v_pk_mul_f32 v[90:91], v[90:91], v[58:59]
    v_cvt_pk_bf16_f32 v96, v80, v81
    v_cvt_pk_bf16_f32 v97, v82, v83
    v_cvt_pk_bf16_f32 v98, v84, v85
    v_cvt_pk_bf16_f32 v99, v86, v87
    v_cvt_pk_bf16_f32 v100, v88, v89
    v_cvt_pk_bf16_f32 v101, v90, v91
    v_mov_b32 v102, 0
    v_mov_b32 v103, 0
    s_waitcnt lgkmcnt(0)
    v_mfma_f32_32x32x16_bf16 v[16:31], v[96:99], v[124:127], v[16:31]
    v_exp_f32 v80, v64
    v_exp_f32 v81, v65
    v_exp_f32 v82, v66
    v_mfma_f32_32x32x16_bf16 v[16:31], v[100:103], v[128:131], v[16:31]
    v_exp_f32 v83, v67
    v_exp_f32 v84, v68
    v_exp_f32 v85, v69
    v_exp_f32 v86, v70
    v_exp_f32 v87, v71
    v_exp_f32 v88, v72
    v_exp_f32 v89, v73
    v_exp_f32 v90, v74
    v_exp_f32 v91, v75
    v_pk_add_f32 v[80:81], v[80:81], 1.0 op_sel_hi:[1,0]
    v_pk_add_f32 v[82:83], v[82:83], 1.0 op_sel_hi:[1,0]
    v_pk_add_f32 v[84:85], v[84:85], 1.0 op_sel_hi:[1,0]
    v_pk_add_f32 v[86:87], v[86:87], 1.0 op_sel_hi:[1,0]
    v_pk_add_f32 v[88:89], v[88:89], 1.0 op_sel_hi:[1,0]
    v_pk_add_f32 v[90:91], v[90:91], 1.0 op_sel_hi:[1,0]
    v_rcp_f32 v80, v80
    v_rcp_f32 v81, v81
    v_rcp_f32 v82, v82
    v_rcp_f32 v83, v83
    v_rcp_f32 v84, v84
    v_rcp_f32 v85, v85
    v_rcp_f32 v86, v86
    v_rcp_f32 v87, v87
    v_rcp_f32 v88, v88
    v_rcp_f32 v89, v89
    v_rcp_f32 v90, v90
    v_rcp_f32 v91, v91
    v_pk_mul_f32 v[80:81], v[80:81], v[64:65]
    v_pk_mul_f32 v[82:83], v[82:83], v[66:67]
    v_pk_mul_f32 v[84:85], v[84:85], v[68:69]
    v_pk_mul_f32 v[86:87], v[86:87], v[70:71]
    v_pk_mul_f32 v[88:89], v[88:89], v[72:73]
    v_pk_mul_f32 v[90:91], v[90:91], v[74:75]
    v_cvt_pk_bf16_f32 v96, v80, v81
    v_cvt_pk_bf16_f32 v97, v82, v83
    v_cvt_pk_bf16_f32 v98, v84, v85
    v_cvt_pk_bf16_f32 v99, v86, v87
    v_cvt_pk_bf16_f32 v100, v88, v89
    v_cvt_pk_bf16_f32 v101, v90, v91
    s_branch K_lend
L_wu:
    s_lshl_b32 s11, s9, 12
    s_add_u32 s11, s11, s10
    s_add_u32 s9, s9, 1
    s_cmp_lg_u32 s9, 1
    s_cbranch_scc1 L_wu0
    buffer_load_dwordx4 v[164:167], v252, s[28:31], s11 offen offset:0 sc1
    buffer_load_dwordx4 v[168:171], v252, s[28:31], s11 offen offset:1024 sc1
    buffer_load_dwordx4 v[172:175], v252, s[28:31], s11 offen offset:2048 sc1
    buffer_load_dwordx4 v[176:179], v252, s[28:31], s11 offen offset:3072 sc1
    s_branch L_wub
L_wu0:
    s_cmp_lg_u32 s9, 2
    s_cbranch_scc1 L_wu1
    buffer_load_dwordx4 v[180:183], v252, s[28:31], s11 offen offset:0 sc1
    buffer_load_dwordx4 v[184:187], v252, s[28:31], s11 offen offset:1024 sc1
    buffer_load_dwordx4 v[188:191], v252, s[28:31], s11 offen offset:2048 sc1
    buffer_load_dwordx4 v[192:195], v252, s[28:31], s11 offen offset:3072 sc1
    s_branch L_wub
L_wu1:
    s_cmp_lg_u32 s9, 3
    s_cbranch_scc1 L_wu2
    buffer_load_dwordx4 v[196:199], v252, s[28:31], s11 offen offset:0 sc1
    buffer_load_dwordx4 v[200:203], v252, s[28:31], s11 offen offset:1024 sc1
    buffer_load_dwordx4 v[204:207], v252, s[28:31], s11 offen offset:2048 sc1
    buffer_load_dwordx4 v[208:211], v252, s[28:31], s11 offen offset:3072 sc1
    s_branch L_wub
L_wu2:
    buffer_load_dwordx4 v[212:215], v252, s[28:31], s11 offen offset:0 sc1
    buffer_load_dwordx4 v[216:219], v252, s[28:31], s11 offen offset:1024 sc1
    buffer_load_dwordx4 v[220:223], v252, s[28:31], s11 offen offset:2048 sc1
    buffer_load_dwordx4 v[224:227], v252, s[28:31], s11 offen offset:3072 sc1
    s_branch L_wub
K_final:
    s_cmp_eq_u32 s9, 4
    s_cbranch_scc1 K_fwu
    buffer_load_dwordx4 v[164:167], v252, s[28:31], s10 offen offset:0 sc1
    buffer_load_dwordx4 v[168:171], v252, s[28:31], s10 offen offset:1024 sc1
    buffer_load_dwordx4 v[172:175], v252, s[28:31], s10 offen offset:2048 sc1
    buffer_load_dwordx4 v[176:179], v252, s[28:31], s10 offen offset:3072 sc1
    s_add_u32 s10, s10, 4096
    buffer_load_dwordx4 v[180:183], v252, s[28:31], s10 offen offset:0 sc1
    buffer_load_dwordx4 v[184:187], v252, s[28:31], s10 offen offset:1024 sc1
    buffer_load_dwordx4 v[188:191], v252, s[28:31], s10 offen offset:2048 sc1
    buffer_load_dwordx4 v[192:195], v252, s[28:31], s10 offen offset:3072 sc1
    s_add_u32 s10, s10, 4096
    buffer_load_dwordx4 v[196:199], v252, s[28:31], s10 offen offset:0 sc1
    buffer_load_dwordx4 v[200:203], v252, s[28:31], s10 offen offset:1024 sc1
    buffer_load_dwordx4 v[204:207], v252, s[28:31], s10 offen offset:2048 sc1
    buffer_load_dwordx4 v[208:211], v252, s[28:31], s10 offen offset:3072 sc1
    s_add_u32 s10, s10, 4096
    buffer_load_dwordx4 v[212:215], v252, s[28:31], s10 offen offset:0 sc1
    buffer_load_dwordx4 v[216:219], v252, s[28:31], s10 offen offset:1024 sc1
    buffer_load_dwordx4 v[220:223], v252, s[28:31], s10 offen offset:2048 sc1
    buffer_load_dwordx4 v[224:227], v252, s[28:31], s10 offen offset:3072 sc1
    s_add_u32 s10, s10, 4096
K_fwu:
    v_add_u32 v1, 158720, v252
    ds_read_b128 v[104:107], v1 offset:0
    ds_read_b128 v[108:111], v1 offset:1024
    ds_read_b128 v[112:115], v1 offset:2048
    s_lshl_b32 s10, s2, 9
    s_lshl_b32 s94, s3, 6
    s_add_u32 s10, s10, s94
    v_mov_b32 v2, 0xbfb8aa3b
    v_add_u32 v6, s18, v252
    v_cvt_pk_bf16_f32 v48, v16, v17
    v_cvt_pk_bf16_f32 v49, v18, v19
    v_cvt_pk_bf16_f32 v50, v20, v21
    v_cvt_pk_bf16_f32 v51, v22, v23
    v_cvt_pk_bf16_f32 v52, v24, v25
    v_cvt_pk_bf16_f32 v53, v26, v27
    v_cvt_pk_bf16_f32 v54, v28, v29
    v_cvt_pk_bf16_f32 v55, v30, v31
    s_waitcnt vmcnt(0) lgkmcnt(0)
    v_add_u32 v107, s18, v107
    v_add_u32 v5, s18, v111
    v_xor_b32 v10, 32, v107
    v_xor_b32 v11, 64, v107
    v_xor_b32 v12, 96, v107
    ds_write_b128 v107, v[48:51]
    ds_write_b128 v10, v[52:55]
    v_cvt_pk_bf16_f32 v56, v32, v33
    v_cvt_pk_bf16_f32 v57, v34, v35
    v_cvt_pk_bf16_f32 v58, v36, v37
    v_cvt_pk_bf16_f32 v59, v38, v39
    v_cvt_pk_bf16_f32 v60, v40, v41
    v_cvt_pk_bf16_f32 v61, v42, v43
    v_cvt_pk_bf16_f32 v62, v44, v45
    v_cvt_pk_bf16_f32 v63, v46, v47
    ds_write_b128 v11, v[56:59]
    ds_write_b128 v12, v[60:63]
    s_waitcnt lgkmcnt(0)
    s_barrier
    ds_read_b128 v[16:19], v108 offset:0
    ds_read_b128 v[20:23], v112 offset:0
    ds_read_b128 v[24:27], v108 offset:10624
    ds_read_b128 v[28:31], v112 offset:10624
    ds_read_b128 v[32:35], v108 offset:21248
    ds_read_b128 v[36:39], v112 offset:21248
    ds_read_b128 v[40:43], v108 offset:31872
    ds_read_b128 v[44:47], v112 offset:31872
    ds_read_b128 v[48:51], v109 offset:0
    ds_read_b128 v[52:55], v113 offset:0
    ds_read_b128 v[56:59], v109 offset:10624
    ds_read_b128 v[60:63], v113 offset:10624
    ds_read_b128 v[64:67], v109 offset:21248
    ds_read_b128 v[68:71], v113 offset:21248
    ds_read_b128 v[72:75], v109 offset:31872
    s_waitcnt lgkmcnt(14)
    ds_read_b128 v[76:79], v113 offset:31872
    s_waitcnt lgkmcnt(15)
    v_mfma_f32_16x16x32_bf16 v[228:231], v[164:167], v[16:19], v[228:231]
    v_mfma_f32_16x16x32_bf16 v[232:235], v[168:171], v[16:19], v[232:235]
    s_waitcnt lgkmcnt(14)
    v_mfma_f32_16x16x32_bf16 v[228:231], v[172:175], v[20:23], v[228:231]
    v_mfma_f32_16x16x32_bf16 v[232:235], v[176:179], v[20:23], v[232:235]
    s_waitcnt lgkmcnt(13)
    v_mfma_f32_16x16x32_bf16 v[228:231], v[180:183], v[24:27], v[228:231]
    v_mfma_f32_16x16x32_bf16 v[232:235], v[184:187], v[24:27], v[232:235]
    s_waitcnt lgkmcnt(12)
    v_mfma_f32_16x16x32_bf16 v[228:231], v[188:191], v[28:31], v[228:231]
    v_mfma_f32_16x16x32_bf16 v[232:235], v[192:195], v[28:31], v[232:235]
    s_waitcnt lgkmcnt(11)
    v_mfma_f32_16x16x32_bf16 v[228:231], v[196:199], v[32:35], v[228:231]
    v_mfma_f32_16x16x32_bf16 v[232:235], v[200:203], v[32:35], v[232:235]
    s_waitcnt lgkmcnt(10)
    v_mfma_f32_16x16x32_bf16 v[228:231], v[204:207], v[36:39], v[228:231]
    v_mfma_f32_16x16x32_bf16 v[232:235], v[208:211], v[36:39], v[232:235]
    s_waitcnt lgkmcnt(9)
    v_mfma_f32_16x16x32_bf16 v[228:231], v[212:215], v[40:43], v[228:231]
    v_mfma_f32_16x16x32_bf16 v[232:235], v[216:219], v[40:43], v[232:235]
    s_waitcnt lgkmcnt(8)
    v_mfma_f32_16x16x32_bf16 v[228:231], v[220:223], v[44:47], v[228:231]
    v_mfma_f32_16x16x32_bf16 v[232:235], v[224:227], v[44:47], v[232:235]
    ds_read_b128 v[116:119], v110 offset:0
    ds_read_b128 v[120:123], v114 offset:0
    ds_read_b128 v[124:127], v110 offset:10624
    ds_read_b128 v[128:131], v114 offset:10624
    ds_read_b128 v[132:135], v110 offset:21248
    ds_read_b128 v[136:139], v114 offset:21248
    ds_read_b128 v[140:143], v110 offset:31872
    s_waitcnt lgkmcnt(14)
    ds_read_b128 v[144:147], v114 offset:31872
    s_waitcnt lgkmcnt(8)
    v_mfma_f32_16x16x32_bf16 v[236:239], v[164:167], v[48:51], v[236:239]
    v_exp_f32 v80, v228
    v_mfma_f32_16x16x32_bf16 v[240:243], v[168:171], v[48:51], v[240:243]
    v_exp_f32 v81, v229
    v_mfma_f32_16x16x32_bf16 v[236:239], v[172:175], v[52:55], v[236:239]
    v_exp_f32 v82, v230
    v_mfma_f32_16x16x32_bf16 v[240:243], v[176:179], v[52:55], v[240:243]
    v_exp_f32 v83, v231
    v_mfma_f32_16x16x32_bf16 v[236:239], v[180:183], v[56:59], v[236:239]
    v_exp_f32 v84, v232
    v_mfma_f32_16x16x32_bf16 v[240:243], v[184:187], v[56:59], v[240:243]
    v_exp_f32 v85, v233
    v_mfma_f32_16x16x32_bf16 v[236:239], v[188:191], v[60:63], v[236:239]
    v_exp_f32 v86, v234
    v_mfma_f32_16x16x32_bf16 v[240:243], v[192:195], v[60:63], v[240:243]
    v_exp_f32 v87, v235
    v_fma_f32 v80, v80, v2, v2
    v_fma_f32 v81, v81, v2, v2
    v_fma_f32 v82, v82, v2, v2
    v_fma_f32 v83, v83, v2, v2
    v_fma_f32 v84, v84, v2, v2
    v_fma_f32 v85, v85, v2, v2
    v_fma_f32 v86, v86, v2, v2
    v_fma_f32 v87, v87, v2, v2
    v_mfma_f32_16x16x32_bf16 v[236:239], v[196:199], v[64:67], v[236:239]
    v_rcp_f32 v80, v80
    v_mfma_f32_16x16x32_bf16 v[240:243], v[200:203], v[64:67], v[240:243]
    v_rcp_f32 v81, v81
    v_mfma_f32_16x16x32_bf16 v[236:239], v[204:207], v[68:71], v[236:239]
    v_rcp_f32 v82, v82
    v_mfma_f32_16x16x32_bf16 v[240:243], v[208:211], v[68:71], v[240:243]
    v_rcp_f32 v83, v83
    v_mfma_f32_16x16x32_bf16 v[236:239], v[212:215], v[72:75], v[236:239]
    v_rcp_f32 v84, v84
    v_mfma_f32_16x16x32_bf16 v[240:243], v[216:219], v[72:75], v[240:243]
    v_rcp_f32 v85, v85
    v_mfma_f32_16x16x32_bf16 v[236:239], v[220:223], v[76:79], v[236:239]
    v_rcp_f32 v86, v86
    v_mfma_f32_16x16x32_bf16 v[240:243], v[224:227], v[76:79], v[240:243]
    v_rcp_f32 v87, v87
    v_mul_f32 v228, v228, v80
    v_mul_f32 v229, v229, v81
    v_mul_f32 v230, v230, v82
    v_mul_f32 v231, v231, v83
    v_mul_f32 v232, v232, v84
    v_mul_f32 v233, v233, v85
    v_mul_f32 v234, v234, v86
    v_mul_f32 v235, v235, v87
    v_cvt_pk_bf16_f32 v88, v228, v229
    v_cvt_pk_bf16_f32 v89, v230, v231
    v_cvt_pk_bf16_f32 v90, v232, v233
    v_cvt_pk_bf16_f32 v91, v234, v235
    ds_write_b128 v5, v[88:91] offset:4096
    ds_read_b128 v[148:151], v6 offset:4096
    s_waitcnt lgkmcnt(2)
    v_mfma_f32_16x16x32_bf16 v[244:247], v[164:167], v[116:119], v[244:247]
    v_exp_f32 v80, v236
    v_mfma_f32_16x16x32_bf16 v[248:251], v[168:171], v[116:119], v[248:251]
    v_exp_f32 v81, v237
    v_mfma_f32_16x16x32_bf16 v[244:247], v[172:175], v[120:123], v[244:247]
    v_exp_f32 v82, v238
    v_mfma_f32_16x16x32_bf16 v[248:251], v[176:179], v[120:123], v[248:251]
    v_exp_f32 v83, v239
    v_mfma_f32_16x16x32_bf16 v[244:247], v[180:183], v[124:127], v[244:247]
    v_exp_f32 v84, v240
    v_mfma_f32_16x16x32_bf16 v[248:251], v[184:187], v[124:127], v[248:251]
    v_exp_f32 v85, v241
    v_mfma_f32_16x16x32_bf16 v[244:247], v[188:191], v[128:131], v[244:247]
    v_exp_f32 v86, v242
    v_mfma_f32_16x16x32_bf16 v[248:251], v[192:195], v[128:131], v[248:251]
    v_exp_f32 v87, v243
    v_fma_f32 v80, v80, v2, v2
    v_fma_f32 v81, v81, v2, v2
    v_fma_f32 v82, v82, v2, v2
    v_fma_f32 v83, v83, v2, v2
    v_fma_f32 v84, v84, v2, v2
    v_fma_f32 v85, v85, v2, v2
    v_fma_f32 v86, v86, v2, v2
    v_fma_f32 v87, v87, v2, v2
    v_mfma_f32_16x16x32_bf16 v[244:247], v[196:199], v[132:135], v[244:247]
    v_rcp_f32 v80, v80
    v_mfma_f32_16x16x32_bf16 v[248:251], v[200:203], v[132:135], v[248:251]
    v_rcp_f32 v81, v81
    v_mfma_f32_16x16x32_bf16 v[244:247], v[204:207], v[136:139], v[244:247]
    v_rcp_f32 v82, v82
    v_mfma_f32_16x16x32_bf16 v[248:251], v[208:211], v[136:139], v[248:251]
    v_rcp_f32 v83, v83
    v_mfma_f32_16x16x32_bf16 v[244:247], v[212:215], v[140:143], v[244:247]
    v_rcp_f32 v84, v84
    v_mfma_f32_16x16x32_bf16 v[248:251], v[216:219], v[140:143], v[248:251]
    v_rcp_f32 v85, v85
    v_mfma_f32_16x16x32_bf16 v[244:247], v[220:223], v[144:147], v[244:247]
    v_rcp_f32 v86, v86
    v_mfma_f32_16x16x32_bf16 v[248:251], v[224:227], v[144:147], v[248:251]
    v_rcp_f32 v87, v87
    v_mul_f32 v236, v236, v80
    v_mul_f32 v237, v237, v81
    v_mul_f32 v238, v238, v82
    v_mul_f32 v239, v239, v83
    v_mul_f32 v240, v240, v84
    v_mul_f32 v241, v241, v85
    v_mul_f32 v242, v242, v86
    v_mul_f32 v243, v243, v87
    v_cvt_pk_bf16_f32 v92, v236, v237
    v_cvt_pk_bf16_f32 v93, v238, v239
    v_cvt_pk_bf16_f32 v94, v240, v241
    v_cvt_pk_bf16_f32 v95, v242, v243
    ds_write_b128 v5, v[92:95] offset:5120
    ds_read_b128 v[152:155], v6 offset:5120
    s_waitcnt lgkmcnt(2)
    buffer_store_dwordx4 v[148:151], v104, s[36:39], s10 offen
    v_exp_f32 v80, v244
    v_exp_f32 v81, v245
    v_exp_f32 v82, v246
    v_exp_f32 v83, v247
    v_exp_f32 v84, v248
    v_exp_f32 v85, v249
    v_exp_f32 v86, v250
    v_exp_f32 v87, v251
    v_fma_f32 v80, v80, v2, v2
    v_fma_f32 v81, v81, v2, v2
    v_fma_f32 v82, v82, v2, v2
    v_fma_f32 v83, v83, v2, v2
    v_fma_f32 v84, v84, v2, v2
    v_fma_f32 v85, v85, v2, v2
    v_fma_f32 v86, v86, v2, v2
    v_fma_f32 v87, v87, v2, v2
    v_rcp_f32 v80, v80
    v_rcp_f32 v81, v81
    v_rcp_f32 v82, v82
    v_rcp_f32 v83, v83
    v_rcp_f32 v84, v84
    v_rcp_f32 v85, v85
    v_rcp_f32 v86, v86
    v_rcp_f32 v87, v87
    v_mul_f32 v244, v244, v80
    v_mul_f32 v245, v245, v81
    v_mul_f32 v246, v246, v82
    v_mul_f32 v247, v247, v83
    v_mul_f32 v248, v248, v84
    v_mul_f32 v249, v249, v85
    v_mul_f32 v250, v250, v86
    v_mul_f32 v251, v251, v87
    v_cvt_pk_bf16_f32 v96, v244, v245
    v_cvt_pk_bf16_f32 v97, v246, v247
    v_cvt_pk_bf16_f32 v98, v248, v249
    v_cvt_pk_bf16_f32 v99, v250, v251
    ds_write_b128 v5, v[96:99] offset:6144
    ds_read_b128 v[156:159], v6 offset:6144
    s_waitcnt lgkmcnt(2)
    buffer_store_dwordx4 v[152:155], v105, s[36:39], s10 offen
    s_waitcnt lgkmcnt(0)
    buffer_store_dwordx4 v[156:159], v106, s[36:39], s10 offen
K_end:
    s_endpgm
.section .rodata,"a"
.p2align 6
.amdhsa_kernel standalone__mpnn_edge_mlp__graph_kernel
  .amdhsa_next_free_vgpr 256
  .amdhsa_next_free_sgpr 102
  .amdhsa_accum_offset 256
  .amdhsa_group_segment_fixed_size 0
  .amdhsa_kernarg_size 72
  .amdhsa_user_sgpr_count 2
  .amdhsa_user_sgpr_kernarg_segment_ptr 1
  .amdhsa_system_sgpr_workgroup_id_x 1
.end_amdhsa_kernel
```
